```python
import torch

def _softmax(x, axis=-1):
    return torch.softmax(x, dim=axis)
def _gelu(x):
    return torch.nn.functional.gelu(x, approximate="tanh")
def _silu(x):
    return torch.nn.functional.silu(x)
def _sigmoid(x):
    return torch.sigmoid(x)
def _layernorm(x, axis=-1, eps=1e-5):
    m = x.mean(dim=axis, keepdim=True)
    v = x.var(dim=axis, keepdim=True, unbiased=False)
    return (x - m) / torch.sqrt(v + eps)
def _scatter_add(tgt, idx, src, axis=0):
    return tgt.clone().index_add_(axis, idx, src)
def _segment_sum(src, seg, n):
    out = torch.zeros((n,) + src.shape[1:], dtype=src.dtype)
    return out.index_add_(0, seg, src)
def _pad(x, pw):
    flat = tuple(v for pair in reversed(pw) for v in pair)
    return torch.nn.functional.pad(x, flat)

kernel_name = 'gated_mix__ssm_conv_s5__ssm_conv_s4d__prompt'

def setup_inputs():

    _w = (lambda a: (lambda t: t.to(torch.bfloat16) if t.is_floating_point() else t)(torch.as_tensor(a)))
    def _A_setup():
        B, S, D = 1, 2048, 512
        P = D
        Lambda_re = -0.5 * (lambda _x: torch.exp(torch.as_tensor(_x)))((lambda *s: torch.randn(*s, dtype=torch.bfloat16) * 0.2)(P))
        Lambda_im = (lambda *s: torch.randn(*s, dtype=torch.bfloat16) * 0.4)(P) * 1.0
        B_re = (lambda *s: torch.randn(*s, dtype=torch.bfloat16) * 0.2)(P, D) * (D ** -0.5)
        B_im = (lambda *s: torch.randn(*s, dtype=torch.bfloat16) * 0.2)(P, D) * (D ** -0.5)
        C_re = (lambda *s: torch.randn(*s, dtype=torch.bfloat16) * 0.2)(D, P) * (P ** -0.5)
        C_im = (lambda *s: torch.randn(*s, dtype=torch.bfloat16) * 0.2)(D, P) * (P ** -0.5)
        log_dt = (lambda *s: torch.randn(*s, dtype=torch.bfloat16) * 0.2)(P) * 0.3 - 2.0
        Dskip = (lambda *s: torch.randn(*s, dtype=torch.bfloat16) * 0.05)(D)
        return {
            "x": _w((lambda *s: torch.randn(*s, dtype=torch.bfloat16) * 0.05)(B, S, D)),
            "Lambda_re": _w(Lambda_re),
            "Lambda_im": _w(Lambda_im),
            "B_re": _w(B_re),
            "B_im": _w(B_im),
            "C_re": _w(C_re),
            "C_im": _w(C_im),
            "log_dt": _w(log_dt),
            "Dskip": _w(Dskip),
        }
    _A_in = _A_setup()

    def _B_setup():
        Bsz, L, D, N = 1, 2048, 512, 128
        return {
            "u": _w((lambda *s: torch.randn(*s, dtype=torch.bfloat16) * 0.05)(Bsz, L, D)),
            "log_A_real": _w((lambda *s: torch.randn(*s, dtype=torch.bfloat16) * 3.2)(D, N) * 0.5),
            "A_imag": _w((lambda *s: torch.randn(*s, dtype=torch.bfloat16) * 0.05)(D, N) * 3.14),
            "C_real": _w((lambda *s: torch.randn(*s, dtype=torch.bfloat16) * 0.1)(D, N) / N ** 0.5),
            "C_imag": _w((lambda *s: torch.randn(*s, dtype=torch.bfloat16) * 0.1)(D, N) / N ** 0.5),
            "log_dt": _w((lambda *s: torch.randn(*s, dtype=torch.bfloat16) * 0.05)(D) * 0.5 - 4.0),
            "D_skip": _w((lambda *s: torch.randn(*s, dtype=torch.bfloat16) * 0.05)(D)),
        }
    _B_in = _B_setup()

    return {
        "A_x": _A_in["x"],
        "A_Lambda_re": _A_in["Lambda_re"],
        "A_Lambda_im": _A_in["Lambda_im"],
        "A_B_re": _A_in["B_re"],
        "A_B_im": _A_in["B_im"],
        "A_C_re": _A_in["C_re"],
        "A_C_im": _A_in["C_im"],
        "A_log_dt": _A_in["log_dt"],
        "A_Dskip": _A_in["Dskip"],
        "B_u": _B_in["u"],
        "B_log_A_real": _B_in["log_A_real"],
        "B_A_imag": _B_in["A_imag"],
        "B_C_real": _B_in["C_real"],
        "B_C_imag": _B_in["C_imag"],
        "B_log_dt": _B_in["log_dt"],
        "B_D_skip": _B_in["D_skip"],
        "gate_w": _w((lambda *s: torch.randn(*s, dtype=torch.bfloat16) * 0.05)(512) * 16.0),
    }

def reference(A_x, A_Lambda_re, A_Lambda_im, A_B_re, A_B_im, A_C_re, A_C_im, A_log_dt, A_Dskip, B_u, B_log_A_real, B_A_imag, B_C_real, B_C_imag, B_log_dt, B_D_skip, gate_w):
    def _A_ref(x, Lambda_re, Lambda_im, B_re, B_im, C_re, C_im, log_dt, Dskip):
        Bsz, L, H = x.shape
        Lam = Lambda_re + 1j * Lambda_im
        Bmat = B_re + 1j * B_im
        Cmat = C_re + 1j * C_im
        dt = torch.exp(log_dt)
        Lam_bar = torch.exp(dt * Lam)
        B_bar = ((Lam_bar - 1.0) / Lam)[:, None] * Bmat
        Bu = torch.einsum("bld,pd->blp", x + 0j, B_bar)
        h = torch.zeros_like(Bu[:, 0, :])
        hs = []
        for t in range(L):
            h = Lam_bar[None, :] * h + Bu[:, t, :]
            hs.append(h)
        hseq = torch.stack(hs, 1)
        y = 2.0 * torch.einsum("blp,dp->bld", hseq, Cmat).real + x * Dskip[None, None, :]
        return y

    def _B_ref(u, log_A_real, A_imag, C_real, C_imag, log_dt, D_skip):
        L = u.shape[1]
        dt = torch.exp(log_dt)
        A = -torch.exp(log_A_real) + 1j * A_imag
        C = (C_real + 1j * C_imag) * dt[:, None]
        pos = (lambda x, dt: x.to(dt))(torch.arange(L), log_dt.dtype)
        P = torch.exp((A * dt[:, None])[:, :, None] * pos[None, None, :])
        K = 2.0 * torch.einsum("dn,dnl->dl", C, P).real
        L2 = 2 * L
        u_t = (lambda x, *d: x.permute(*d))(u, 0, 2, 1)
        Kf = (lambda x, *a, **k: torch.fft.rfft(x.float(), *a, **k))(K, L2)
        Uf = (lambda x, *a, **k: torch.fft.rfft(x.float(), *a, **k))(u_t, L2)
        y = (lambda x, *a, **k: torch.fft.irfft(x, *a, **k).to(torch.bfloat16))(Uf * Kf[None, :, :], L2)[:, :, :L]
        y = (lambda x, *d: x.permute(*d))(y, 0, 2, 1)
        return y + u * D_skip[None, None, :]

    x = A_x
    g = _sigmoid((x * gate_w).sum(-1, keepdims=True))
    a = _A_ref(x, A_Lambda_re, A_Lambda_im, A_B_re, A_B_im, A_C_re, A_C_im, A_log_dt, A_Dskip)
    b = _B_ref(x, B_log_A_real, B_A_imag, B_C_real, B_C_imag, B_log_dt, B_D_skip)
    return g * a + (1 - g) * b
```

```asm
; @launch grid=(256,1,1) block=(512,1,1) lds=163840
.amdgcn_target "amdgcn-amd-amdhsa--gfx950"
.text
.globl gated_mix__ssm_conv_s5__ssm_conv_s4d__prompt_kernel
.p2align 8
.type gated_mix__ssm_conv_s5__ssm_conv_s4d__prompt_kernel,@function
gated_mix__ssm_conv_s5__ssm_conv_s4d__prompt_kernel:
    s_cmp_ge_u32 s2, 256
    s_cbranch_scc1 L_F_end
    s_cmp_lt_u32 s2, 16
    s_cbranch_scc0 L_F_nopf
    v_lshrrev_b32 v2, 6, v0
    s_nop 0
    v_readfirstlane_b32 s4, v2
    s_nop 0
    s_cmp_eq_u32 s4, 7
    s_cbranch_scc0 L_F_nopf
    s_getpc_b64 s[4:5]
L_F_pc:
    s_lshr_b32 s6, s2, 3
    s_mul_i32 s6, s6, 16384
    v_and_b32 v1, 63, v0
    v_lshlrev_b32 v1, 7, v1
    v_add_u32 v1, s6, v1
    v_min_u32 v3, L_F_last-L_F_pc, v1
    global_load_dword v255, v3, s[4:5]
    v_add_u32 v1, 8192, v1
    v_min_u32 v3, L_F_last-L_F_pc, v1
    global_load_dword v255, v3, s[4:5]
L_F_nopf:
    s_cmp_ge_u32 s2, 128
    s_cbranch_scc1 L_F_A
    s_load_dwordx4 s[20:23], s[0:1], 80
    s_load_dwordx4 s[24:27], s[0:1], 96
    s_load_dwordx4 s[28:31], s[0:1], 112
    s_load_dwordx2 s[8:9], s[0:1], 0
    s_load_dwordx2 s[16:17], s[0:1], 152
    s_load_dwordx2 s[64:65], s[0:1], 144
    s_load_dwordx4 s[56:59], s[0:1], 24
    v_lshrrev_b32 v2, 6, v0
    v_and_b32 v1, 63, v0
    s_and_b32 s33, s2, 7
    v_readfirstlane_b32 s32, v2
    s_lshr_b32 s34, s2, 3
    s_and_b32 s34, s34, 15
    s_lshl_b32 s35, s33, 6
    s_lshl_b32 s36, s34, 2
    s_add_u32 s35, s35, s36
    s_lshr_b32 s37, s32, 1
    s_and_b32 s38, s32, 1
    s_add_u32 s39, s35, s37
    v_and_b32 v3, 127, v0
    s_lshl_b32 s40, s39, 8
    v_lshl_add_u32 v4, v3, 1, s40
    s_lshl_b32 s41, s39, 1
    v_mov_b32 v5, s41
    s_waitcnt lgkmcnt(0)
    global_load_ushort v8, v4, s[20:21]
    global_load_ushort v12, v5, s[28:29]
    global_load_ushort v9, v4, s[22:23]
    global_load_ushort v10, v4, s[24:25]
    global_load_ushort v11, v4, s[26:27]
    global_load_ushort v13, v5, s[30:31]
    s_mov_b32 s10, 0x200000
    s_mov_b32 s11, 0x20000
    s_mov_b32 s18, 0x700000
    s_mov_b32 s19, 0x20000
    s_lshl_b32 s42, s34, 7
    s_lshl_b32 s43, s32, 4
    s_add_u32 s42, s42, s43
    v_and_b32 v6, 15, v1
    v_add_u32 v6, s42, v6
    v_lshlrev_b32 v6, 10, v6
    s_lshl_b32 s44, s35, 1
    v_lshlrev_b32 v7, 12, v0
    s_barrier
    buffer_load_dword v14, v6, s[8:11], s44 offen
    buffer_load_dwordx2 v[16:17], v7, s[8:11], s44 offen offset:0
    s_mul_i32 s45, s37, 36864
    v_lshlrev_b32 v3, 2, v3
    v_add_u32 v3, s45, v3
    v_xor_b32 v24, 0, v3
    v_xor_b32 v25, 32, v3
    v_xor_b32 v26, 64, v3
    v_xor_b32 v27, 96, v3
    v_xor_b32 v28, 128, v3
    v_xor_b32 v29, 160, v3
    v_xor_b32 v30, 192, v3
    v_xor_b32 v31, 224, v3
    s_branch L_B_rest
L_F_A:
    s_load_dwordx4 s[20:23], s[0:1], 8
    s_load_dwordx2 s[24:25], s[0:1], 56
    s_load_dwordx2 s[8:9], s[0:1], 0
    s_load_dwordx4 s[28:31], s[0:1], 24
    s_load_dwordx2 s[26:27], s[0:1], 128
    s_load_dwordx4 s[64:67], s[0:1], 144
    s_memrealtime s[68:69]
    v_lshrrev_b32 v2, 6, v0
    v_and_b32 v1, 63, v0
    s_and_b32 s33, s2, 7
    v_readfirstlane_b32 s32, v2
    s_lshr_b32 s34, s2, 3
    s_sub_u32 s34, s34, 16
    s_lshr_b32 s35, s34, 3
    s_lshl_b32 s37, s33, 1
    s_add_u32 s37, s37, s35
    s_and_b32 s38, s34, 7
    s_lshl_b32 s39, s38, 1
    s_add_u32 s39, s39, s33
    s_add_u32 s39, s39, s35
    s_and_b32 s39, s39, 7
    v_lshrrev_b32 v8, 3, v1
    v_and_b32 v9, 7, v1
    v_lshrrev_b32 v10, 1, v8
    v_xor_b32 v11, v9, v10
    v_xor_b32 v12, 4, v11
    v_lshlrev_b32 v13, 10, v8
    v_lshl_add_u32 v4, v11, 4, v13
    v_lshl_add_u32 v5, v12, 4, v13
    v_add_u32 v5, 0x2000, v5
    s_lshl_b32 s40, s37, 17
    s_lshl_b32 s41, s32, 14
    s_add_u32 s40, s40, s41
    s_and_b32 s42, s32, 3
    s_lshl_b32 s42, s42, 14
    s_lshl_b32 s43, s38, 16
    s_add_u32 s42, s42, s43
    v_add_u32 v6, s42, v4
    v_add_u32 v7, s42, v5
    v_add_u32 v4, s40, v4
    v_add_u32 v5, s40, v5
    s_and_b32 s44, s32, 1
    s_lshr_b32 s45, s32, 1
    s_lshl_b32 s46, s38, 6
    s_lshl_b32 s47, s44, 5
    s_add_u32 s46, s46, s47
    v_and_b32 v14, 31, v1
    v_add_u32 v14, s46, v14
    v_lshlrev_b32 v15, 1, v14
    s_lshl_b32 s48, s37, 7
    s_lshl_b32 s49, s38, 4
    s_add_u32 s48, s48, s49
    s_lshl_b32 s49, s32, 1
    s_add_u32 s48, s48, s49
    s_lshl_b32 s49, s48, 10
    v_lshlrev_b32 v3, 4, v1
    s_lshl_b32 s50, s32, 11
    s_waitcnt lgkmcnt(0)
    s_mov_b32 s10, 0x200000
    s_mov_b32 s11, 0x20000
    s_cmp_lt_u32 s32, 4
    s_cselect_b32 s12, s28, s30
    s_cselect_b32 s13, s29, s31
    s_mov_b32 s14, 0x80000
    s_mov_b32 s15, 0x20000
    s_mov_b32 s16, s66
    s_mov_b32 s17, s67
    s_mov_b32 s18, 0x700000
    s_mov_b32 s19, 0x20000
    s_load_dwordx4 s[28:31], s[0:1], 40
    global_load_ushort v18, v15, s[24:25]
    global_load_ushort v16, v15, s[20:21]
    global_load_ushort v17, v15, s[22:23]
    s_add_u32 s51, s39, 0
    s_and_b32 s51, s51, 7
    s_lshl_b32 s51, s51, 7
    s_add_u32 m0, s50, 0
    s_nop 0
    buffer_load_dwordx4 v4, s[8:11], s51 offen lds
    s_add_u32 m0, s50, 16384
    s_nop 0
    buffer_load_dwordx4 v6, s[12:15], s51 offen lds
    s_add_u32 m0, s50, 1024
    s_nop 0
    buffer_load_dwordx4 v5, s[8:11], s51 offen lds
    s_add_u32 m0, s50, 17408
    s_nop 0
    buffer_load_dwordx4 v7, s[12:15], s51 offen lds
    s_barrier
    s_add_u32 s51, s39, 1
    s_and_b32 s51, s51, 7
    s_lshl_b32 s51, s51, 7
    s_add_u32 m0, s50, 32768
    s_nop 0
    buffer_load_dwordx4 v4, s[8:11], s51 offen lds
    s_add_u32 m0, s50, 49152
    s_nop 0
    buffer_load_dwordx4 v6, s[12:15], s51 offen lds
    s_add_u32 m0, s50, 33792
    s_nop 0
    buffer_load_dwordx4 v5, s[8:11], s51 offen lds
    s_add_u32 m0, s50, 50176
    s_nop 0
    buffer_load_dwordx4 v7, s[12:15], s51 offen lds
    s_cmp_eq_u32 s2, 128
    s_cbranch_scc0 L_A_nonw
    s_cmp_eq_u32 s32, 0
    s_cbranch_scc0 L_A_nonw
    s_or_b32 s70, s68, 1
    v_mov_b32 v32, s70
    v_lshlrev_b32 v33, 6, v1
    s_mov_b64 exec, 15
    global_store_dword v33, v32, s[64:65] sc1
    s_mov_b64 exec, -1
L_A_nonw:
    v_mov_b32 v32, 0
    v_mov_b32 v33, 0
    v_lshlrev_b32 v34, 3, v0
    v_add_u32 v34, 131072, v34
    s_cmp_lt_u32 s32, 7
    s_cbranch_scc0 L_A_nozero
    ds_write_b64 v34, v[32:33]
L_A_nozero:
    v_and_b32 v8, 31, v1
    v_lshrrev_b32 v9, 5, v1
    v_bfe_u32 v10, v8, 2, 1
    v_lshlrev_b32 v10, 4, v10
    v_lshrrev_b32 v11, 3, v8
    v_lshl_add_u32 v10, v11, 1, v10
    v_and_b32 v11, 1, v8
    v_lshl_add_u32 v10, v11, 3, v10
    v_bfe_u32 v11, v8, 1, 1
    v_add_u32 v10, v10, v11
    v_bfe_u32 v11, v10, 1, 3
    v_xor_b32 v11, v11, v9
    v_lshlrev_b32 v11, 4, v11
    s_lshl_b32 s54, s45, 12
    v_lshl_add_u32 v11, v10, 7, v11
    v_add_u32 v36, s54, v11
    v_bfe_u32 v11, v8, 1, 3
    v_xor_b32 v11, v11, v9
    v_lshlrev_b32 v11, 4, v11
    v_lshl_add_u32 v11, v8, 7, v11
    s_lshl_b32 s54, s44, 12
    s_add_u32 s54, s54, 16384
    v_add_u32 v40, s54, v11
    v_xor_b32 v37, 32, v36
    v_xor_b32 v41, 32, v40
    v_xor_b32 v38, 64, v36
    v_xor_b32 v42, 64, v40
    v_xor_b32 v39, 96, v36
    v_xor_b32 v43, 96, v40
    v_mov_b32 v64, 0
    v_mov_b32 v65, 0
    v_mov_b32 v66, 0
    v_mov_b32 v67, 0
    v_mov_b32 v68, 0
    v_mov_b32 v69, 0
    v_mov_b32 v70, 0
    v_mov_b32 v71, 0
    v_mov_b32 v72, 0
    v_mov_b32 v73, 0
    v_mov_b32 v74, 0
    v_mov_b32 v75, 0
    v_mov_b32 v76, 0
    v_mov_b32 v77, 0
    v_mov_b32 v78, 0
    v_mov_b32 v79, 0
    v_mov_b32 v80, 0
    v_mov_b32 v81, 0
    v_mov_b32 v82, 0
    v_mov_b32 v83, 0
    v_mov_b32 v84, 0
    v_mov_b32 v85, 0
    v_mov_b32 v86, 0
    v_mov_b32 v87, 0
    v_mov_b32 v88, 0
    v_mov_b32 v89, 0
    v_mov_b32 v90, 0
    v_mov_b32 v91, 0
    v_mov_b32 v92, 0
    v_mov_b32 v93, 0
    v_mov_b32 v94, 0
    v_mov_b32 v95, 0
    s_waitcnt vmcnt(8)
    v_lshlrev_b32 v18, 16, v18
    v_lshlrev_b32 v16, 16, v16
    v_lshlrev_b32 v17, 16, v17
    v_mul_f32 v52, 0x3fb8aa3b, v18
    v_exp_f32 v52, v52
    s_nop 0
    v_cvt_pk_bf16_f32 v52, v52, v52
    v_and_b32 v52, 0xffff0000, v52
    v_mul_f32 v44, v52, v16
    v_mul_f32 v45, v52, v17
    v_mul_f32 v44, 0x3fb8aa3b, v44
    v_mul_f32 v45, 0x3e22f983, v45
    v_exp_f32 v52, v44
    v_fract_f32 v53, v45
    v_cos_f32 v46, v53
    v_sin_f32 v47, v53
    v_mul_f32 v46, v46, v52
    v_mul_f32 v47, v47, v52
    v_add_f32 v52, -1.0, v46
    v_mul_f32 v53, v16, v16
    v_fmac_f32 v53, v17, v17
    v_rcp_f32 v53, v53
    v_mul_f32 v54, v52, v16
    v_fmac_f32 v54, v47, v17
    v_mul_f32 v55, v52, v17
    v_fma_f32 v55, v47, v16, -v55
    v_mul_f32 v48, v54, v53
    v_mul_f32 v49, v55, v53
    v_xor_b32 v58, 0x80000000, v47
    v_xor_b32 v59, 0x80000000, v49
    v_mul_f32 v52, 0x41800000, v44
    v_mul_f32 v53, 0x41800000, v45
    v_exp_f32 v52, v52
    v_fract_f32 v53, v53
    v_cos_f32 v50, v53
    v_sin_f32 v51, v53
    v_mul_f32 v50, v50, v52
    v_mul_f32 v51, v51, v52
    v_mul_f32 v52, 0x41000000, v44
    v_mul_f32 v53, 0x41000000, v45
    v_exp_f32 v52, v52
    v_fract_f32 v53, v53
    v_cos_f32 v32, v53
    v_sin_f32 v33, v53
    v_mul_f32 v32, v32, v52
    v_mul_f32 v33, v33, v52
    v_lshrrev_b32 v8, 5, v1
    s_lshl_b32 s54, s45, 1
    v_add_u32 v8, s54, v8
    v_lshlrev_b32 v9, 4, v8
    v_cvt_f32_u32 v9, v9
    v_mul_f32 v52, v9, v44
    v_mul_f32 v53, v9, v45
    v_exp_f32 v52, v52
    v_fract_f32 v53, v53
    v_cos_f32 v60, v53
    v_sin_f32 v61, v53
    v_mul_f32 v60, v60, v52
    v_mul_f32 v61, v61, v52
    s_cmp_eq_u32 s45, 0
    s_cbranch_scc0 L_A_noz
    v_and_b32 v9, 31, v1
    s_lshl_b32 s54, s44, 5
    v_add_u32 v9, s54, v9
    v_lshlrev_b32 v9, 3, v9
    v_add_u32 v9, 139264, v9
    ds_write_b64 v9, v[44:45]
L_A_noz:
    s_load_dwordx2 s[24:25], s[0:1], 64
    s_waitcnt vmcnt(4)
    s_barrier
    s_add_u32 s51, s39, 2
    s_and_b32 s51, s51, 7
    s_lshl_b32 s51, s51, 7
    s_add_u32 m0, s50, 65536
    s_nop 0
    buffer_load_dwordx4 v4, s[8:11], s51 offen lds
    s_add_u32 m0, s50, 81920
    s_nop 0
    buffer_load_dwordx4 v6, s[12:15], s51 offen lds
    s_add_u32 m0, s50, 66560
    s_nop 0
    buffer_load_dwordx4 v5, s[8:11], s51 offen lds
    s_add_u32 m0, s50, 82944
    s_nop 0
    buffer_load_dwordx4 v7, s[12:15], s51 offen lds
    ds_read_b128 v[96:99], v36 offset:0
    ds_read_b128 v[100:103], v40 offset:0
    ds_read_b128 v[104:107], v40 offset:8192
    ds_read_b128 v[108:111], v37 offset:0
    ds_read_b128 v[112:115], v41 offset:0
    ds_read_b128 v[116:119], v41 offset:8192
    ds_read_b128 v[120:123], v38 offset:0
    ds_read_b128 v[124:127], v42 offset:0
    ds_read_b128 v[128:131], v42 offset:8192
    ds_read_b128 v[132:135], v39 offset:0
    ds_read_b128 v[136:139], v43 offset:0
    ds_read_b128 v[140:143], v43 offset:8192
    s_waitcnt lgkmcnt(0)
    s_waitcnt vmcnt(4)
    s_barrier
    s_add_u32 s51, s39, 3
    s_and_b32 s51, s51, 7
    s_lshl_b32 s51, s51, 7
    s_add_u32 m0, s50, 98304
    s_nop 0
    buffer_load_dwordx4 v4, s[8:11], s51 offen lds
    s_add_u32 m0, s50, 114688
    s_nop 0
    buffer_load_dwordx4 v6, s[12:15], s51 offen lds
    s_add_u32 m0, s50, 99328
    s_nop 0
    buffer_load_dwordx4 v5, s[8:11], s51 offen lds
    s_add_u32 m0, s50, 115712
    s_nop 0
    buffer_load_dwordx4 v7, s[12:15], s51 offen lds
    v_mfma_f32_32x32x16_bf16 v[64:79], v[96:99], v[100:103], v[64:79]
    ds_read_b128 v[144:147], v36 offset:32768
    ds_read_b128 v[148:151], v40 offset:32768
    v_mfma_f32_32x32x16_bf16 v[80:95], v[96:99], v[104:107], v[80:95]
    ds_read_b128 v[152:155], v40 offset:40960
    ds_read_b128 v[156:159], v37 offset:32768
    v_mfma_f32_32x32x16_bf16 v[64:79], v[108:111], v[112:115], v[64:79]
    ds_read_b128 v[160:163], v41 offset:32768
    ds_read_b128 v[164:167], v41 offset:40960
    v_mfma_f32_32x32x16_bf16 v[80:95], v[108:111], v[116:119], v[80:95]
    ds_read_b128 v[168:171], v38 offset:32768
    v_mfma_f32_32x32x16_bf16 v[64:79], v[120:123], v[124:127], v[64:79]
    ds_read_b128 v[172:175], v42 offset:32768
    ds_read_b128 v[176:179], v42 offset:40960
    v_mfma_f32_32x32x16_bf16 v[80:95], v[120:123], v[128:131], v[80:95]
    ds_read_b128 v[180:183], v39 offset:32768
    ds_read_b128 v[184:187], v43 offset:32768
    v_mfma_f32_32x32x16_bf16 v[64:79], v[132:135], v[136:139], v[64:79]
    ds_read_b128 v[188:191], v43 offset:40960
    v_mfma_f32_32x32x16_bf16 v[80:95], v[132:135], v[140:143], v[80:95]
    s_waitcnt lgkmcnt(0)
    s_waitcnt vmcnt(4)
    s_barrier
    v_xor_b32 v36, 0x10000, v36
    v_xor_b32 v40, 0x10000, v40
    v_xor_b32 v37, 0x10000, v37
    v_xor_b32 v41, 0x10000, v41
    v_xor_b32 v38, 0x10000, v38
    v_xor_b32 v42, 0x10000, v42
    v_xor_b32 v39, 0x10000, v39
    v_xor_b32 v43, 0x10000, v43
    s_add_u32 s51, s39, 4
    s_and_b32 s51, s51, 7
    s_lshl_b32 s51, s51, 7
    s_add_u32 m0, s50, 0
    s_nop 0
    buffer_load_dwordx4 v4, s[8:11], s51 offen lds
    s_add_u32 m0, s50, 16384
    s_nop 0
    buffer_load_dwordx4 v6, s[12:15], s51 offen lds
    s_add_u32 m0, s50, 1024
    s_nop 0
    buffer_load_dwordx4 v5, s[8:11], s51 offen lds
    s_add_u32 m0, s50, 17408
    s_nop 0
    buffer_load_dwordx4 v7, s[12:15], s51 offen lds
    s_and_b32 s46, s2, 7
    s_lshr_b32 s51, s2, 3
    s_and_b32 s7, s51, 7
    s_lshr_b32 s51, s51, 3
    s_lshl_b32 s6, s46, 2
    s_add_u32 s6, s6, s51
    s_and_b32 s3, s7, 1
    s_lshl_b32 s3, s3, 2
    s_lshl_b32 s4, s6, 6
    s_lshl_b32 s5, s7, 6
    v_lshrrev_b32 v26, 3, v1
    v_and_b32 v27, 7, v1
    v_lshrrev_b32 v28, 1, v26
    v_xor_b32 v27, v27, v28
    v_xor_b32 v28, 4, v27
    v_lshlrev_b32 v26, 10, v26
    v_lshl_add_u32 v192, v27, 4, v26
    v_lshl_add_u32 v193, v28, 4, v26
    v_add_u32 v193, 0x2000, v193
    s_and_b32 s46, s32, 3
    s_lshl_b32 s46, s46, 4
    s_add_u32 s46, s46, s5
    s_lshl_b32 s46, s46, 10
    v_add_u32 v192, s46, v192
    v_add_u32 v193, s46, v193
    v_mfma_f32_32x32x16_bf16 v[64:79], v[144:147], v[148:151], v[64:79]
    ds_read_b128 v[96:99], v36 offset:0
    ds_read_b128 v[100:103], v40 offset:0
    v_mfma_f32_32x32x16_bf16 v[80:95], v[144:147], v[152:155], v[80:95]
    ds_read_b128 v[104:107], v40 offset:8192
    ds_read_b128 v[108:111], v37 offset:0
    v_mfma_f32_32x32x16_bf16 v[64:79], v[156:159], v[160:163], v[64:79]
    ds_read_b128 v[112:115], v41 offset:0
    ds_read_b128 v[116:119], v41 offset:8192
    v_mfma_f32_32x32x16_bf16 v[80:95], v[156:159], v[164:167], v[80:95]
    ds_read_b128 v[120:123], v38 offset:0
    v_mfma_f32_32x32x16_bf16 v[64:79], v[168:171], v[172:175], v[64:79]
    ds_read_b128 v[124:127], v42 offset:0
    ds_read_b128 v[128:131], v42 offset:8192
    v_mfma_f32_32x32x16_bf16 v[80:95], v[168:171], v[176:179], v[80:95]
    ds_read_b128 v[132:135], v39 offset:0
    ds_read_b128 v[136:139], v43 offset:0
    v_mfma_f32_32x32x16_bf16 v[64:79], v[180:183], v[184:187], v[64:79]
    ds_read_b128 v[140:143], v43 offset:8192
    v_mfma_f32_32x32x16_bf16 v[80:95], v[180:183], v[188:191], v[80:95]
    s_waitcnt lgkmcnt(0)
    s_waitcnt vmcnt(4)
    s_barrier
    s_cmp_eq_u32 s32, 0
    s_cbranch_scc0 L_A_nonr
    s_bfe_u32 s54, s2, 0x20003
    s_lshl_b32 s54, s54, 6
    v_mov_b32 v34, s54
    global_load_dword v35, v34, s[64:65] sc1
L_A_nonr:
    s_add_u32 s51, s39, 5
    s_and_b32 s51, s51, 7
    s_lshl_b32 s51, s51, 7
    s_add_u32 m0, s50, 32768
    s_nop 0
    buffer_load_dwordx4 v4, s[8:11], s51 offen lds
    s_add_u32 m0, s50, 49152
    s_nop 0
    buffer_load_dwordx4 v6, s[12:15], s51 offen lds
    s_add_u32 m0, s50, 33792
    s_nop 0
    buffer_load_dwordx4 v5, s[8:11], s51 offen lds
    s_add_u32 m0, s50, 50176
    s_nop 0
    buffer_load_dwordx4 v7, s[12:15], s51 offen lds
    v_mfma_f32_32x32x16_bf16 v[64:79], v[96:99], v[100:103], v[64:79]
    ds_read_b128 v[144:147], v36 offset:32768
    ds_read_b128 v[148:151], v40 offset:32768
    v_mfma_f32_32x32x16_bf16 v[80:95], v[96:99], v[104:107], v[80:95]
    ds_read_b128 v[152:155], v40 offset:40960
    ds_read_b128 v[156:159], v37 offset:32768
    v_mfma_f32_32x32x16_bf16 v[64:79], v[108:111], v[112:115], v[64:79]
    ds_read_b128 v[160:163], v41 offset:32768
    ds_read_b128 v[164:167], v41 offset:40960
    v_mfma_f32_32x32x16_bf16 v[80:95], v[108:111], v[116:119], v[80:95]
    ds_read_b128 v[168:171], v38 offset:32768
    v_mfma_f32_32x32x16_bf16 v[64:79], v[120:123], v[124:127], v[64:79]
    ds_read_b128 v[172:175], v42 offset:32768
    ds_read_b128 v[176:179], v42 offset:40960
    v_mfma_f32_32x32x16_bf16 v[80:95], v[120:123], v[128:131], v[80:95]
    ds_read_b128 v[180:183], v39 offset:32768
    ds_read_b128 v[184:187], v43 offset:32768
    v_mfma_f32_32x32x16_bf16 v[64:79], v[132:135], v[136:139], v[64:79]
    ds_read_b128 v[188:191], v43 offset:40960
    v_mfma_f32_32x32x16_bf16 v[80:95], v[132:135], v[140:143], v[80:95]
    s_waitcnt lgkmcnt(0)
    s_waitcnt vmcnt(4)
    s_barrier
    v_xor_b32 v36, 0x10000, v36
    v_xor_b32 v40, 0x10000, v40
    v_xor_b32 v37, 0x10000, v37
    v_xor_b32 v41, 0x10000, v41
    v_xor_b32 v38, 0x10000, v38
    v_xor_b32 v42, 0x10000, v42
    v_xor_b32 v39, 0x10000, v39
    v_xor_b32 v43, 0x10000, v43
    s_add_u32 s51, s39, 6
    s_and_b32 s51, s51, 7
    s_lshl_b32 s51, s51, 7
    s_add_u32 m0, s50, 65536
    s_nop 0
    buffer_load_dwordx4 v4, s[8:11], s51 offen lds
    s_add_u32 m0, s50, 81920
    s_nop 0
    buffer_load_dwordx4 v6, s[12:15], s51 offen lds
    s_add_u32 m0, s50, 66560
    s_nop 0
    buffer_load_dwordx4 v5, s[8:11], s51 offen lds
    s_add_u32 m0, s50, 82944
    s_nop 0
    buffer_load_dwordx4 v7, s[12:15], s51 offen lds
    v_mfma_f32_32x32x16_bf16 v[64:79], v[144:147], v[148:151], v[64:79]
    ds_read_b128 v[96:99], v36 offset:0
    ds_read_b128 v[100:103], v40 offset:0
    v_mfma_f32_32x32x16_bf16 v[80:95], v[144:147], v[152:155], v[80:95]
    ds_read_b128 v[104:107], v40 offset:8192
    ds_read_b128 v[108:111], v37 offset:0
    v_mfma_f32_32x32x16_bf16 v[64:79], v[156:159], v[160:163], v[64:79]
    ds_read_b128 v[112:115], v41 offset:0
    ds_read_b128 v[116:119], v41 offset:8192
    v_mfma_f32_32x32x16_bf16 v[80:95], v[156:159], v[164:167], v[80:95]
    ds_read_b128 v[120:123], v38 offset:0
    v_mfma_f32_32x32x16_bf16 v[64:79], v[168:171], v[172:175], v[64:79]
    ds_read_b128 v[124:127], v42 offset:0
    ds_read_b128 v[128:131], v42 offset:8192
    v_mfma_f32_32x32x16_bf16 v[80:95], v[168:171], v[176:179], v[80:95]
    ds_read_b128 v[132:135], v39 offset:0
    ds_read_b128 v[136:139], v43 offset:0
    v_mfma_f32_32x32x16_bf16 v[64:79], v[180:183], v[184:187], v[64:79]
    ds_read_b128 v[140:143], v43 offset:8192
    v_mfma_f32_32x32x16_bf16 v[80:95], v[180:183], v[188:191], v[80:95]
    s_waitcnt lgkmcnt(0)
    s_waitcnt vmcnt(4)
    s_barrier
    s_add_u32 s51, s39, 7
    s_and_b32 s51, s51, 7
    s_lshl_b32 s51, s51, 7
    s_add_u32 m0, s50, 98304
    s_nop 0
    buffer_load_dwordx4 v4, s[8:11], s51 offen lds
    s_add_u32 m0, s50, 114688
    s_nop 0
    buffer_load_dwordx4 v6, s[12:15], s51 offen lds
    s_add_u32 m0, s50, 99328
    s_nop 0
    buffer_load_dwordx4 v5, s[8:11], s51 offen lds
    s_add_u32 m0, s50, 115712
    s_nop 0
    buffer_load_dwordx4 v7, s[12:15], s51 offen lds
    s_cmp_eq_u32 s32, 0
    s_cbranch_scc0 L_A_nonc
    s_mov_b32 s55, 0x8000
L_A_nonp:
    v_readfirstlane_b32 s70, v35
    s_nop 0
    s_cmp_lg_u32 s70, 0
    s_cbranch_scc1 L_A_nong
    global_load_dword v35, v34, s[64:65] sc1
    s_waitcnt vmcnt(0)
    s_sub_u32 s55, s55, 1
    s_cmp_lg_u32 s55, 0
    s_cbranch_scc1 L_A_nonp
L_A_nong:
    v_mov_b32 v34, 139776
    ds_write_b32 v34, v35
L_A_nonc:
    v_mfma_f32_32x32x16_bf16 v[64:79], v[96:99], v[100:103], v[64:79]
    ds_read_b128 v[144:147], v36 offset:32768
    ds_read_b128 v[148:151], v40 offset:32768
    v_mfma_f32_32x32x16_bf16 v[80:95], v[96:99], v[104:107], v[80:95]
    ds_read_b128 v[152:155], v40 offset:40960
    ds_read_b128 v[156:159], v37 offset:32768
    v_mfma_f32_32x32x16_bf16 v[64:79], v[108:111], v[112:115], v[64:79]
    ds_read_b128 v[160:163], v41 offset:32768
    ds_read_b128 v[164:167], v41 offset:40960
    v_mfma_f32_32x32x16_bf16 v[80:95], v[108:111], v[116:119], v[80:95]
    ds_read_b128 v[168:171], v38 offset:32768
    v_mfma_f32_32x32x16_bf16 v[64:79], v[120:123], v[124:127], v[64:79]
    ds_read_b128 v[172:175], v42 offset:32768
    ds_read_b128 v[176:179], v42 offset:40960
    v_mfma_f32_32x32x16_bf16 v[80:95], v[120:123], v[128:131], v[80:95]
    ds_read_b128 v[180:183], v39 offset:32768
    ds_read_b128 v[184:187], v43 offset:32768
    v_mfma_f32_32x32x16_bf16 v[64:79], v[132:135], v[136:139], v[64:79]
    ds_read_b128 v[188:191], v43 offset:40960
    v_mfma_f32_32x32x16_bf16 v[80:95], v[132:135], v[140:143], v[80:95]
    s_waitcnt lgkmcnt(0)
    s_waitcnt vmcnt(4)
    s_barrier
    v_xor_b32 v36, 0x10000, v36
    v_xor_b32 v40, 0x10000, v40
    v_xor_b32 v37, 0x10000, v37
    v_xor_b32 v41, 0x10000, v41
    v_xor_b32 v38, 0x10000, v38
    v_xor_b32 v42, 0x10000, v42
    v_xor_b32 v39, 0x10000, v39
    v_xor_b32 v43, 0x10000, v43
    global_load_dwordx4 v[28:31], v3, s[26:27]
    buffer_load_dwordx4 v[20:23], v3, s[8:11], s49 offen
    buffer_load_dwordx4 v[24:27], v3, s[8:11], s49 offen offset:1024
    global_load_dword v194, v3, s[24:25]
    v_mfma_f32_32x32x16_bf16 v[64:79], v[144:147], v[148:151], v[64:79]
    ds_read_b128 v[96:99], v36 offset:0
    ds_read_b128 v[100:103], v40 offset:0
    v_mfma_f32_32x32x16_bf16 v[80:95], v[144:147], v[152:155], v[80:95]
    ds_read_b128 v[104:107], v40 offset:8192
    ds_read_b128 v[108:111], v37 offset:0
    v_mfma_f32_32x32x16_bf16 v[64:79], v[156:159], v[160:163], v[64:79]
    ds_read_b128 v[112:115], v41 offset:0
    ds_read_b128 v[116:119], v41 offset:8192
    v_mfma_f32_32x32x16_bf16 v[80:95], v[156:159], v[164:167], v[80:95]
    ds_read_b128 v[120:123], v38 offset:0
    v_mfma_f32_32x32x16_bf16 v[64:79], v[168:171], v[172:175], v[64:79]
    ds_read_b128 v[124:127], v42 offset:0
    ds_read_b128 v[128:131], v42 offset:8192
    v_mfma_f32_32x32x16_bf16 v[80:95], v[168:171], v[176:179], v[80:95]
    ds_read_b128 v[132:135], v39 offset:0
    ds_read_b128 v[136:139], v43 offset:0
    v_mfma_f32_32x32x16_bf16 v[64:79], v[180:183], v[184:187], v[64:79]
    ds_read_b128 v[140:143], v43 offset:8192
    v_mfma_f32_32x32x16_bf16 v[80:95], v[180:183], v[188:191], v[80:95]
    s_waitcnt lgkmcnt(0)
    s_waitcnt vmcnt(4)
    s_barrier
    v_mfma_f32_32x32x16_bf16 v[64:79], v[96:99], v[100:103], v[64:79]
    ds_read_b128 v[144:147], v36 offset:32768
    ds_read_b128 v[148:151], v40 offset:32768
    v_mfma_f32_32x32x16_bf16 v[80:95], v[96:99], v[104:107], v[80:95]
    ds_read_b128 v[152:155], v40 offset:40960
    ds_read_b128 v[156:159], v37 offset:32768
    v_mfma_f32_32x32x16_bf16 v[64:79], v[108:111], v[112:115], v[64:79]
    ds_read_b128 v[160:163], v41 offset:32768
    ds_read_b128 v[164:167], v41 offset:40960
    v_mfma_f32_32x32x16_bf16 v[80:95], v[108:111], v[116:119], v[80:95]
    ds_read_b128 v[168:171], v38 offset:32768
    v_mfma_f32_32x32x16_bf16 v[64:79], v[120:123], v[124:127], v[64:79]
    ds_read_b128 v[172:175], v42 offset:32768
    ds_read_b128 v[176:179], v42 offset:40960
    v_mfma_f32_32x32x16_bf16 v[80:95], v[120:123], v[128:131], v[80:95]
    ds_read_b128 v[180:183], v39 offset:32768
    ds_read_b128 v[184:187], v43 offset:32768
    v_mfma_f32_32x32x16_bf16 v[64:79], v[132:135], v[136:139], v[64:79]
    ds_read_b128 v[188:191], v43 offset:40960
    v_mfma_f32_32x32x16_bf16 v[80:95], v[132:135], v[140:143], v[80:95]
    s_waitcnt lgkmcnt(0)
    v_mfma_f32_32x32x16_bf16 v[64:79], v[144:147], v[148:151], v[64:79]
    s_cmp_lt_u32 s32, 4
    s_cselect_b32 s12, s28, s30
    s_cselect_b32 s13, s29, s31
    s_mov_b32 s14, 0x80000
    s_mov_b32 s15, 0x20000
    v_mfma_f32_32x32x16_bf16 v[80:95], v[144:147], v[152:155], v[80:95]
    s_add_u32 s51, s3, 0
    s_and_b32 s51, s51, 7
    s_lshl_b32 s51, s51, 7
    s_lshl_b32 s54, s32, 11
    s_add_u32 m0, s54, 0
    s_nop 0
    buffer_load_dwordx4 v192, s[12:15], s51 offen lds
    s_add_u32 m0, s54, 1024
    s_nop 0
    buffer_load_dwordx4 v193, s[12:15], s51 offen lds
    v_mfma_f32_32x32x16_bf16 v[64:79], v[156:159], v[160:163], v[64:79]
    s_add_u32 s51, s3, 1
    s_and_b32 s51, s51, 7
    s_lshl_b32 s51, s51, 7
    s_lshl_b32 s54, s32, 11
    s_add_u32 m0, s54, 16384
    s_nop 0
    buffer_load_dwordx4 v192, s[12:15], s51 offen lds
    s_add_u32 m0, s54, 17408
    s_nop 0
    buffer_load_dwordx4 v193, s[12:15], s51 offen lds
    v_mfma_f32_32x32x16_bf16 v[80:95], v[156:159], v[164:167], v[80:95]
    s_add_u32 s51, s3, 2
    s_and_b32 s51, s51, 7
    s_lshl_b32 s51, s51, 7
    s_lshl_b32 s54, s32, 11
    s_add_u32 m0, s54, 32768
    s_nop 0
    buffer_load_dwordx4 v192, s[12:15], s51 offen lds
    s_add_u32 m0, s54, 33792
    s_nop 0
    buffer_load_dwordx4 v193, s[12:15], s51 offen lds
    v_mfma_f32_32x32x16_bf16 v[64:79], v[168:171], v[172:175], v[64:79]
    s_add_u32 s51, s3, 3
    s_and_b32 s51, s51, 7
    s_lshl_b32 s51, s51, 7
    s_lshl_b32 s54, s32, 11
    s_add_u32 m0, s54, 49152
    s_nop 0
    buffer_load_dwordx4 v192, s[12:15], s51 offen lds
    s_add_u32 m0, s54, 50176
    s_nop 0
    buffer_load_dwordx4 v193, s[12:15], s51 offen lds
    v_mfma_f32_32x32x16_bf16 v[80:95], v[168:171], v[176:179], v[80:95]
    v_mfma_f32_32x32x16_bf16 v[64:79], v[180:183], v[184:187], v[64:79]
    v_mfma_f32_32x32x16_bf16 v[80:95], v[180:183], v[188:191], v[80:95]
    v_mov_b32 v34, 139776
    ds_read_b32 v35, v34
    v_lshlrev_b32 v34, 3, v1
    v_add_u32 v34, 139264, v34
    ds_read_b64 v[62:63], v34
    v_mov_b32 v36, v46
    v_mov_b32 v37, v46
    v_mov_b32 v38, v47
    v_mov_b32 v39, v47
    s_nop 1
    v_mov_b32 v112, v64
    v_mov_b32 v114, v80
    v_mov_b32 v113, v65
    v_mov_b32 v115, v81
    v_pk_fma_f32 v[116:117], v[114:115], v[38:39], v[66:67] neg_lo:[0,1,0] neg_hi:[0,1,0]
    v_pk_fma_f32 v[118:119], v[112:113], v[38:39], v[82:83]
    v_pk_fma_f32 v[112:113], v[112:113], v[36:37], v[116:117]
    v_pk_fma_f32 v[114:115], v[114:115], v[36:37], v[118:119]
    v_pk_fma_f32 v[116:117], v[114:115], v[38:39], v[68:69] neg_lo:[0,1,0] neg_hi:[0,1,0]
    v_pk_fma_f32 v[118:119], v[112:113], v[38:39], v[84:85]
    v_pk_fma_f32 v[112:113], v[112:113], v[36:37], v[116:117]
    v_pk_fma_f32 v[114:115], v[114:115], v[36:37], v[118:119]
    v_pk_fma_f32 v[116:117], v[114:115], v[38:39], v[70:71] neg_lo:[0,1,0] neg_hi:[0,1,0]
    v_pk_fma_f32 v[118:119], v[112:113], v[38:39], v[86:87]
    v_pk_fma_f32 v[112:113], v[112:113], v[36:37], v[116:117]
    v_pk_fma_f32 v[114:115], v[114:115], v[36:37], v[118:119]
    v_pk_fma_f32 v[116:117], v[114:115], v[38:39], v[72:73] neg_lo:[0,1,0] neg_hi:[0,1,0]
    v_pk_fma_f32 v[118:119], v[112:113], v[38:39], v[88:89]
    v_pk_fma_f32 v[112:113], v[112:113], v[36:37], v[116:117]
    v_pk_fma_f32 v[114:115], v[114:115], v[36:37], v[118:119]
    v_pk_fma_f32 v[116:117], v[114:115], v[38:39], v[74:75] neg_lo:[0,1,0] neg_hi:[0,1,0]
    v_pk_fma_f32 v[118:119], v[112:113], v[38:39], v[90:91]
    v_pk_fma_f32 v[112:113], v[112:113], v[36:37], v[116:117]
    v_pk_fma_f32 v[114:115], v[114:115], v[36:37], v[118:119]
    v_pk_fma_f32 v[116:117], v[114:115], v[38:39], v[76:77] neg_lo:[0,1,0] neg_hi:[0,1,0]
    v_pk_fma_f32 v[118:119], v[112:113], v[38:39], v[92:93]
    v_pk_fma_f32 v[112:113], v[112:113], v[36:37], v[116:117]
    v_pk_fma_f32 v[114:115], v[114:115], v[36:37], v[118:119]
    v_pk_fma_f32 v[116:117], v[114:115], v[38:39], v[78:79] neg_lo:[0,1,0] neg_hi:[0,1,0]
    v_pk_fma_f32 v[118:119], v[112:113], v[38:39], v[94:95]
    v_pk_fma_f32 v[112:113], v[112:113], v[36:37], v[116:117]
    v_pk_fma_f32 v[114:115], v[114:115], v[36:37], v[118:119]
    v_fma_f32 v56, v32, v112, v113
    v_fma_f32 v57, v32, v114, v115
    v_fma_f32 v56, -v33, v114, v56
    v_fma_f32 v57, v33, v112, v57
    v_and_b32 v9, 31, v1
    s_lshl_b32 s54, s44, 5
    v_add_u32 v9, s54, v9
    v_lshlrev_b32 v10, 3, v9
    v_lshl_add_u32 v9, v8, 9, v10
    v_add_u32 v9, 131072, v9
    ds_write_b64 v9, v[56:57] offset:3584
    s_waitcnt lgkmcnt(0)
    s_barrier
    s_cmp_eq_u32 s45, 3
    s_cbranch_scc0 L_A_noprio
    s_setprio 2
L_A_noprio:
    ds_read_b64 v[96:97], v9 offset:0
    ds_read_b64 v[98:99], v9 offset:512
    ds_read_b64 v[100:101], v9 offset:1024
    ds_read_b64 v[102:103], v9 offset:1536
    ds_read_b64 v[104:105], v9 offset:2048
    ds_read_b64 v[106:107], v9 offset:2560
    ds_read_b64 v[108:109], v9 offset:3072
    s_waitcnt lgkmcnt(5)
    v_pk_fma_f32 v[98:99], v[96:97], v[50:51], v[98:99] op_sel:[1,1,0] op_sel_hi:[1,0,1] neg_lo:[0,1,0]
    v_pk_fma_f32 v[98:99], v[96:97], v[50:51], v[98:99] op_sel_hi:[0,1,1]
    s_waitcnt lgkmcnt(4)
    v_pk_fma_f32 v[100:101], v[98:99], v[50:51], v[100:101] op_sel:[1,1,0] op_sel_hi:[1,0,1] neg_lo:[0,1,0]
    v_pk_fma_f32 v[100:101], v[98:99], v[50:51], v[100:101] op_sel_hi:[0,1,1]
    s_waitcnt lgkmcnt(3)
    v_pk_fma_f32 v[102:103], v[100:101], v[50:51], v[102:103] op_sel:[1,1,0] op_sel_hi:[1,0,1] neg_lo:[0,1,0]
    v_pk_fma_f32 v[102:103], v[100:101], v[50:51], v[102:103] op_sel_hi:[0,1,1]
    s_waitcnt lgkmcnt(2)
    v_pk_fma_f32 v[104:105], v[102:103], v[50:51], v[104:105] op_sel:[1,1,0] op_sel_hi:[1,0,1] neg_lo:[0,1,0]
    v_pk_fma_f32 v[104:105], v[102:103], v[50:51], v[104:105] op_sel_hi:[0,1,1]
    s_waitcnt lgkmcnt(1)
    v_pk_fma_f32 v[106:107], v[104:105], v[50:51], v[106:107] op_sel:[1,1,0] op_sel_hi:[1,0,1] neg_lo:[0,1,0]
    v_pk_fma_f32 v[106:107], v[104:105], v[50:51], v[106:107] op_sel_hi:[0,1,1]
    s_waitcnt lgkmcnt(0)
    v_pk_fma_f32 v[108:109], v[106:107], v[50:51], v[108:109] op_sel:[1,1,0] op_sel_hi:[1,0,1] neg_lo:[0,1,0]
    v_pk_fma_f32 v[108:109], v[106:107], v[50:51], v[108:109] op_sel_hi:[0,1,1]
    s_cmp_eq_u32 s45, 3
    s_cbranch_scc0 L_A_noE
    v_pk_fma_f32 v[56:57], v[108:109], v[50:51], v[56:57] op_sel:[1,1,0] op_sel_hi:[1,0,1] neg_lo:[0,1,0]
    v_pk_fma_f32 v[56:57], v[108:109], v[50:51], v[56:57] op_sel_hi:[0,1,1]
    v_pk_mul_f32 v[116:117], v[56:57], v[48:49] op_sel:[1,1] op_sel_hi:[1,0] neg_lo:[0,1]
    v_pk_fma_f32 v[116:117], v[56:57], v[48:49], v[116:117] op_sel_hi:[0,1,1]
    v_mov_b32 v136, v116
    v_mov_b32 v137, v35
    v_mov_b32 v138, v117
    v_mov_b32 v139, v35
    s_lshl_b32 s54, s37, 13
    s_add_u32 s54, s54, 0x600000
    v_lshlrev_b32 v140, 4, v14
    s_mov_b32 exec_lo, 0
    buffer_store_dwordx4 v[136:139], v140, s[16:19], s54 offen sc1
    s_mov_b32 exec_lo, -1
    s_setprio 0
L_A_noE:
    s_add_u32 s51, s3, 4
    s_and_b32 s51, s51, 7
    s_lshl_b32 s51, s51, 7
    s_lshl_b32 s54, s32, 11
    s_add_u32 m0, s54, 65536
    s_nop 0
    buffer_load_dwordx4 v192, s[12:15], s51 offen lds
    s_add_u32 m0, s54, 66560
    s_nop 0
    buffer_load_dwordx4 v193, s[12:15], s51 offen lds
    s_add_u32 s51, s3, 5
    s_and_b32 s51, s51, 7
    s_lshl_b32 s51, s51, 7
    s_lshl_b32 s54, s32, 11
    s_add_u32 m0, s54, 81920
    s_nop 0
    buffer_load_dwordx4 v192, s[12:15], s51 offen lds
    s_add_u32 m0, s54, 82944
    s_nop 0
    buffer_load_dwordx4 v193, s[12:15], s51 offen lds
    v_pk_mul_f32 v[52:53], v[64:65], v[48:49] op_sel:[0,1] op_sel_hi:[1,1]
    v_pk_mul_f32 v[64:65], v[64:65], v[48:49] op_sel:[0,0] op_sel_hi:[1,0]
    v_pk_fma_f32 v[64:65], v[80:81], v[48:49], v[64:65] op_sel:[0,1,0] op_sel_hi:[1,1,1] neg_lo:[0,1,0] neg_hi:[0,1,0]
    v_pk_fma_f32 v[80:81], v[80:81], v[48:49], v[52:53] op_sel:[0,0,0] op_sel_hi:[1,0,1]
    v_pk_mul_f32 v[52:53], v[66:67], v[48:49] op_sel:[0,1] op_sel_hi:[1,1]
    v_pk_mul_f32 v[66:67], v[66:67], v[48:49] op_sel:[0,0] op_sel_hi:[1,0]
    v_pk_fma_f32 v[66:67], v[82:83], v[48:49], v[66:67] op_sel:[0,1,0] op_sel_hi:[1,1,1] neg_lo:[0,1,0] neg_hi:[0,1,0]
    v_pk_fma_f32 v[82:83], v[82:83], v[48:49], v[52:53] op_sel:[0,0,0] op_sel_hi:[1,0,1]
    v_pk_mul_f32 v[52:53], v[68:69], v[48:49] op_sel:[0,1] op_sel_hi:[1,1]
    v_pk_mul_f32 v[68:69], v[68:69], v[48:49] op_sel:[0,0] op_sel_hi:[1,0]
    v_pk_fma_f32 v[68:69], v[84:85], v[48:49], v[68:69] op_sel:[0,1,0] op_sel_hi:[1,1,1] neg_lo:[0,1,0] neg_hi:[0,1,0]
    v_pk_fma_f32 v[84:85], v[84:85], v[48:49], v[52:53] op_sel:[0,0,0] op_sel_hi:[1,0,1]
    v_pk_mul_f32 v[52:53], v[70:71], v[48:49] op_sel:[0,1] op_sel_hi:[1,1]
    v_pk_mul_f32 v[70:71], v[70:71], v[48:49] op_sel:[0,0] op_sel_hi:[1,0]
    v_pk_fma_f32 v[70:71], v[86:87], v[48:49], v[70:71] op_sel:[0,1,0] op_sel_hi:[1,1,1] neg_lo:[0,1,0] neg_hi:[0,1,0]
    v_pk_fma_f32 v[86:87], v[86:87], v[48:49], v[52:53] op_sel:[0,0,0] op_sel_hi:[1,0,1]
    v_pk_mul_f32 v[52:53], v[72:73], v[48:49] op_sel:[0,1] op_sel_hi:[1,1]
    v_pk_mul_f32 v[72:73], v[72:73], v[48:49] op_sel:[0,0] op_sel_hi:[1,0]
    v_pk_fma_f32 v[72:73], v[88:89], v[48:49], v[72:73] op_sel:[0,1,0] op_sel_hi:[1,1,1] neg_lo:[0,1,0] neg_hi:[0,1,0]
    v_pk_fma_f32 v[88:89], v[88:89], v[48:49], v[52:53] op_sel:[0,0,0] op_sel_hi:[1,0,1]
    v_pk_mul_f32 v[52:53], v[74:75], v[48:49] op_sel:[0,1] op_sel_hi:[1,1]
    v_pk_mul_f32 v[74:75], v[74:75], v[48:49] op_sel:[0,0] op_sel_hi:[1,0]
    v_pk_fma_f32 v[74:75], v[90:91], v[48:49], v[74:75] op_sel:[0,1,0] op_sel_hi:[1,1,1] neg_lo:[0,1,0] neg_hi:[0,1,0]
    v_pk_fma_f32 v[90:91], v[90:91], v[48:49], v[52:53] op_sel:[0,0,0] op_sel_hi:[1,0,1]
    v_pk_mul_f32 v[52:53], v[76:77], v[48:49] op_sel:[0,1] op_sel_hi:[1,1]
    v_pk_mul_f32 v[76:77], v[76:77], v[48:49] op_sel:[0,0] op_sel_hi:[1,0]
    v_pk_fma_f32 v[76:77], v[92:93], v[48:49], v[76:77] op_sel:[0,1,0] op_sel_hi:[1,1,1] neg_lo:[0,1,0] neg_hi:[0,1,0]
    v_pk_fma_f32 v[92:93], v[92:93], v[48:49], v[52:53] op_sel:[0,0,0] op_sel_hi:[1,0,1]
    v_pk_mul_f32 v[52:53], v[78:79], v[48:49] op_sel:[0,1] op_sel_hi:[1,1]
    v_pk_mul_f32 v[78:79], v[78:79], v[48:49] op_sel:[0,0] op_sel_hi:[1,0]
    v_pk_fma_f32 v[78:79], v[94:95], v[48:49], v[78:79] op_sel:[0,1,0] op_sel_hi:[1,1,1] neg_lo:[0,1,0] neg_hi:[0,1,0]
    v_pk_fma_f32 v[94:95], v[94:95], v[48:49], v[52:53] op_sel:[0,0,0] op_sel_hi:[1,0,1]
    v_pk_mul_f32 v[116:117], v[108:109], v[48:49] op_sel:[1,1] op_sel_hi:[1,0] neg_lo:[0,1]
    v_pk_fma_f32 v[116:117], v[108:109], v[48:49], v[116:117] op_sel_hi:[0,1,1]
    v_mov_b64 v[108:109], v[116:117]
    v_mul_f32 v116, v48, v112
    v_mul_f32 v117, v48, v114
    v_fma_f32 v116, -v49, v114, v116
    v_fma_f32 v117, v49, v112, v117
    v_mov_b32 v112, v116
    v_mov_b32 v114, v117
    s_sub_u32 s56, s37, 1
    s_sub_u32 s56, s56, s32
    s_sub_u32 s57, s56, 8
    s_max_i32 s58, s56, 0
    s_max_i32 s59, s57, 0
    s_lshl_b32 s58, s58, 7
    s_lshl_b32 s59, s59, 7
    v_cvt_f32_u32 v141, s58
    v_cvt_f32_u32 v142, s59
    v_mul_f32 v52, v141, v62
    v_mul_f32 v53, v141, v63
    v_exp_f32 v52, v52
    v_fract_f32 v53, v53
    v_cos_f32 v144, v53
    v_sin_f32 v145, v53
    v_mul_f32 v144, v144, v52
    v_mul_f32 v145, v145, v52
    v_mul_f32 v52, v142, v62
    v_mul_f32 v53, v142, v63
    v_exp_f32 v52, v52
    v_fract_f32 v53, v53
    v_cos_f32 v146, v53
    v_sin_f32 v147, v53
    v_mul_f32 v146, v146, v52
    v_mul_f32 v147, v147, v52
    s_waitcnt vmcnt(12)
    v_lshlrev_b32 v124, 16, v20
    v_lshlrev_b32 v125, 16, v28
    v_and_b32 v126, 0xffff0000, v20
    v_and_b32 v127, 0xffff0000, v28
    v_mul_f32 v148, v124, v125
    v_fmac_f32 v148, v126, v127
    v_lshlrev_b32 v124, 16, v21
    v_lshlrev_b32 v125, 16, v29
    v_and_b32 v126, 0xffff0000, v21
    v_and_b32 v127, 0xffff0000, v29
    v_fmac_f32 v148, v124, v125
    v_fmac_f32 v148, v126, v127
    v_lshlrev_b32 v124, 16, v22
    v_lshlrev_b32 v125, 16, v30
    v_and_b32 v126, 0xffff0000, v22
    v_and_b32 v127, 0xffff0000, v30
    v_fmac_f32 v148, v124, v125
    v_fmac_f32 v148, v126, v127
    v_lshlrev_b32 v124, 16, v23
    v_lshlrev_b32 v125, 16, v31
    v_and_b32 v126, 0xffff0000, v23
    v_and_b32 v127, 0xffff0000, v31
    v_fmac_f32 v148, v124, v125
    v_fmac_f32 v148, v126, v127
    v_lshlrev_b32 v124, 16, v24
    v_lshlrev_b32 v125, 16, v28
    v_and_b32 v126, 0xffff0000, v24
    v_and_b32 v127, 0xffff0000, v28
    v_mul_f32 v149, v124, v125
    v_fmac_f32 v149, v126, v127
    v_lshlrev_b32 v124, 16, v25
    v_lshlrev_b32 v125, 16, v29
    v_and_b32 v126, 0xffff0000, v25
    v_and_b32 v127, 0xffff0000, v29
    v_fmac_f32 v149, v124, v125
    v_fmac_f32 v149, v126, v127
    v_lshlrev_b32 v124, 16, v26
    v_lshlrev_b32 v125, 16, v30
    v_and_b32 v126, 0xffff0000, v26
    v_and_b32 v127, 0xffff0000, v30
    v_fmac_f32 v149, v124, v125
    v_fmac_f32 v149, v126, v127
    v_lshlrev_b32 v124, 16, v27
    v_lshlrev_b32 v125, 16, v31
    v_and_b32 v126, 0xffff0000, v27
    v_and_b32 v127, 0xffff0000, v31
    v_fmac_f32 v149, v124, v125
    v_fmac_f32 v149, v126, v127
    v_add_f32_dpp v148, v148, v148 row_ror:8 row_mask:0xf bank_mask:0xf
    s_nop 0
    v_add_f32_dpp v149, v149, v149 row_ror:8 row_mask:0xf bank_mask:0xf
    v_add_f32_dpp v148, v148, v148 row_ror:4 row_mask:0xf bank_mask:0xf
    s_nop 0
    v_add_f32_dpp v149, v149, v149 row_ror:4 row_mask:0xf bank_mask:0xf
    v_add_f32_dpp v148, v148, v148 row_ror:2 row_mask:0xf bank_mask:0xf
    s_nop 0
    v_add_f32_dpp v149, v149, v149 row_ror:2 row_mask:0xf bank_mask:0xf
    v_add_f32_dpp v148, v148, v148 row_ror:1 row_mask:0xf bank_mask:0xf
    s_nop 0
    v_add_f32_dpp v149, v149, v149 row_ror:1 row_mask:0xf bank_mask:0xf
    v_readlane_b32 s56, v148, 0
    v_readlane_b32 s57, v148, 16
    v_readlane_b32 s58, v148, 32
    v_readlane_b32 s59, v148, 48
    v_readlane_b32 s60, v149, 0
    v_readlane_b32 s61, v149, 16
    v_readlane_b32 s62, v149, 32
    v_readlane_b32 s63, v149, 48
    v_mov_b32 v148, s56
    v_mov_b32 v149, s60
    v_add_f32 v148, s57, v148
    v_add_f32 v149, s61, v149
    v_add_f32 v148, s58, v148
    v_add_f32 v149, s62, v149
    v_add_f32 v148, s59, v148
    v_add_f32 v149, s63, v149
    v_cmp_eq_u32 vcc, 1, v1
    s_nop 1
    v_cndmask_b32 v148, v148, v149, vcc
    v_cvt_pk_bf16_f32 v148, v148, v148
    v_and_b32 v148, 0xffff0000, v148
    v_mul_f32 v148, 0x3fb8aa3b, v148
    v_exp_f32 v148, -v148
    s_nop 0
    v_add_f32 v148, 1.0, v148
    v_rcp_f32 v148, v148
    v_add_u32 v149, s48, v1
    v_lshlrev_b32 v149, 2, v149
    v_add_u32 v149, 0x620000, v149
    v_cvt_pk_bf16_f32 v148, v148, v148
    v_and_b32 v148, 0xffff0000, v148
    s_mov_b64 exec, 3
    buffer_store_dword v148, v149, s[16:19], 0 offen sc1
    s_mov_b64 exec, -1
    v_mov_b32 v132, 0
    v_mov_b32 v133, 0
    s_lshl_b32 s56, s38, 10
    s_add_u32 s56, s56, 0x600000
    s_lshl_b32 s57, s32, 13
    s_add_u32 s56, s56, s57
    s_add_u32 s57, s56, 65536
    v_lshlrev_b32 v150, 4, v1
    v_readfirstlane_b32 s71, v35
    s_cmp_lt_u32 s32, s37
    s_cbranch_scc0 L_A_pdone
    s_add_u32 s58, s32, 8
    s_cmp_lt_u32 s58, s37
    s_cselect_b32 s59, 1, 0
    s_mov_b32 s55, 0x8000
L_A_poll:
    buffer_load_dwordx4 v[124:127], v150, s[16:19], s56 offen sc1
    s_cmp_eq_u32 s59, 1
    s_cbranch_scc0 L_A_poll1
    buffer_load_dwordx4 v[128:131], v150, s[16:19], s57 offen sc1
    s_waitcnt vmcnt(0)
    v_cmp_ne_u32 vcc, s71, v129
    v_cmp_ne_u32 s[60:61], s71, v131
    s_nop 0
    s_or_b64 s[62:63], vcc, s[60:61]
    s_branch L_A_poll2
L_A_poll1:
    s_waitcnt vmcnt(0)
    s_mov_b64 s[62:63], 0
L_A_poll2:
    v_cmp_ne_u32 vcc, s71, v125
    v_cmp_ne_u32 s[60:61], s71, v127
    s_nop 0
    s_or_b64 vcc, vcc, s[60:61]
    s_or_b64 vcc, vcc, s[62:63]
    s_cbranch_vccz L_A_pok
    s_sub_u32 s55, s55, 1
    s_cmp_lg_u32 s55, 0
    s_cbranch_scc1 L_A_poll
L_A_pok:
    v_mov_b32 v125, v126
    v_mov_b32 v129, v130
    v_pk_mul_f32 v[132:133], v[124:125], v[144:145] op_sel:[1,1] op_sel_hi:[1,0] neg_lo:[0,1]
    v_pk_fma_f32 v[132:133], v[124:125], v[144:145], v[132:133] op_sel_hi:[0,1,1]
    s_cmp_eq_u32 s59, 1
    s_cbranch_scc0 L_A_pdone
    v_pk_fma_f32 v[132:133], v[128:129], v[146:147], v[132:133] op_sel:[1,1,0] op_sel_hi:[1,0,1] neg_lo:[0,1,0]
    v_pk_fma_f32 v[132:133], v[128:129], v[146:147], v[132:133] op_sel_hi:[0,1,1]
L_A_pdone:
    s_lshl_b32 s54, s32, 9
    s_add_u32 s54, s54, 143360
    v_lshlrev_b32 v150, 3, v1
    v_add_u32 v150, s54, v150
    ds_write_b64 v150, v[132:133]
    v_add_u32 v150, 143360, v10
    v_lshrrev_b32 v8, 5, v1
    v_lshlrev_b32 v8, 8, v8
    v_lshrrev_b32 v9, 3, v14
    v_lshl_add_u32 v8, v9, 15, v8
    v_and_b32 v9, 7, v14
    v_lshrrev_b32 v11, 5, v1
    v_lshlrev_b32 v11, 2, v11
    v_xor_b32 v9, v9, v11
    v_lshl_add_u32 v8, v9, 4, v8
    s_lshl_b32 s54, s37, 11
    s_lshl_b32 s55, s45, 9
    s_add_u32 s54, s54, s55
    s_add_u32 s55, s54, 0x200000
    s_load_dwordx2 s[8:9], s[0:1], 0
    s_load_dwordx2 s[20:21], s[0:1], 136
    s_waitcnt lgkmcnt(0)
    s_barrier
    ds_read_b64 v[152:153], v150 offset:0
    ds_read_b64 v[154:155], v150 offset:512
    ds_read_b64 v[156:157], v150 offset:1024
    ds_read_b64 v[158:159], v150 offset:1536
    ds_read_b64 v[160:161], v150 offset:2048
    ds_read_b64 v[162:163], v150 offset:2560
    ds_read_b64 v[164:165], v150 offset:3072
    ds_read_b64 v[166:167], v150 offset:3584
    s_waitcnt lgkmcnt(6)
    v_pk_add_f32 v[152:153], v[152:153], v[154:155]
    s_waitcnt lgkmcnt(5)
    v_pk_add_f32 v[152:153], v[152:153], v[156:157]
    s_waitcnt lgkmcnt(4)
    v_pk_add_f32 v[152:153], v[152:153], v[158:159]
    s_waitcnt lgkmcnt(3)
    v_pk_add_f32 v[152:153], v[152:153], v[160:161]
    s_waitcnt lgkmcnt(2)
    v_pk_add_f32 v[152:153], v[152:153], v[162:163]
    s_waitcnt lgkmcnt(1)
    v_pk_add_f32 v[152:153], v[152:153], v[164:165]
    s_waitcnt lgkmcnt(0)
    v_pk_add_f32 v[152:153], v[152:153], v[166:167]
    v_pk_fma_f32 v[108:109], v[152:153], v[60:61], v[108:109] op_sel:[1,1,0] op_sel_hi:[1,0,1] neg_lo:[0,1,0]
    v_pk_fma_f32 v[108:109], v[152:153], v[60:61], v[108:109] op_sel_hi:[0,1,1]
    v_mov_b32 v120, v108
    v_mov_b32 v122, v109
    v_fma_f32 v121, v32, v108, v112
    v_fma_f32 v123, v32, v109, v114
    v_fma_f32 v121, -v33, v109, v121
    v_fma_f32 v123, v33, v108, v123
    v_pk_fma_f32 v[64:65], v[120:121], v[46:47], v[64:65] op_sel:[0,0,0] op_sel_hi:[1,0,1]
    v_pk_fma_f32 v[80:81], v[122:123], v[46:47], v[80:81] op_sel:[0,0,0] op_sel_hi:[1,0,1]
    v_pk_fma_f32 v[64:65], v[122:123], v[46:47], v[64:65] op_sel:[0,1,0] op_sel_hi:[1,1,1] neg_lo:[0,1,0] neg_hi:[0,1,0]
    v_pk_fma_f32 v[80:81], v[120:121], v[46:47], v[80:81] op_sel:[0,1,0] op_sel_hi:[1,1,1]
    v_pk_fma_f32 v[66:67], v[64:65], v[46:47], v[66:67] op_sel:[0,0,0] op_sel_hi:[1,0,1]
    v_pk_fma_f32 v[82:83], v[80:81], v[46:47], v[82:83] op_sel:[0,0,0] op_sel_hi:[1,0,1]
    v_pk_fma_f32 v[66:67], v[80:81], v[46:47], v[66:67] op_sel:[0,1,0] op_sel_hi:[1,1,1] neg_lo:[0,1,0] neg_hi:[0,1,0]
    v_pk_fma_f32 v[82:83], v[64:65], v[46:47], v[82:83] op_sel:[0,1,0] op_sel_hi:[1,1,1]
    v_pk_fma_f32 v[68:69], v[66:67], v[46:47], v[68:69] op_sel:[0,0,0] op_sel_hi:[1,0,1]
    v_pk_fma_f32 v[84:85], v[82:83], v[46:47], v[84:85] op_sel:[0,0,0] op_sel_hi:[1,0,1]
    v_pk_fma_f32 v[68:69], v[82:83], v[46:47], v[68:69] op_sel:[0,1,0] op_sel_hi:[1,1,1] neg_lo:[0,1,0] neg_hi:[0,1,0]
    v_pk_fma_f32 v[84:85], v[66:67], v[46:47], v[84:85] op_sel:[0,1,0] op_sel_hi:[1,1,1]
    v_pk_fma_f32 v[70:71], v[68:69], v[46:47], v[70:71] op_sel:[0,0,0] op_sel_hi:[1,0,1]
    v_pk_fma_f32 v[86:87], v[84:85], v[46:47], v[86:87] op_sel:[0,0,0] op_sel_hi:[1,0,1]
    v_pk_fma_f32 v[70:71], v[84:85], v[46:47], v[70:71] op_sel:[0,1,0] op_sel_hi:[1,1,1] neg_lo:[0,1,0] neg_hi:[0,1,0]
    v_pk_fma_f32 v[86:87], v[68:69], v[46:47], v[86:87] op_sel:[0,1,0] op_sel_hi:[1,1,1]
    v_pk_fma_f32 v[72:73], v[70:71], v[46:47], v[72:73] op_sel:[0,0,0] op_sel_hi:[1,0,1]
    v_pk_fma_f32 v[88:89], v[86:87], v[46:47], v[88:89] op_sel:[0,0,0] op_sel_hi:[1,0,1]
    v_pk_fma_f32 v[72:73], v[86:87], v[46:47], v[72:73] op_sel:[0,1,0] op_sel_hi:[1,1,1] neg_lo:[0,1,0] neg_hi:[0,1,0]
    v_pk_fma_f32 v[88:89], v[70:71], v[46:47], v[88:89] op_sel:[0,1,0] op_sel_hi:[1,1,1]
    v_pk_fma_f32 v[74:75], v[72:73], v[46:47], v[74:75] op_sel:[0,0,0] op_sel_hi:[1,0,1]
    v_pk_fma_f32 v[90:91], v[88:89], v[46:47], v[90:91] op_sel:[0,0,0] op_sel_hi:[1,0,1]
    v_pk_fma_f32 v[74:75], v[88:89], v[46:47], v[74:75] op_sel:[0,1,0] op_sel_hi:[1,1,1] neg_lo:[0,1,0] neg_hi:[0,1,0]
    v_pk_fma_f32 v[90:91], v[72:73], v[46:47], v[90:91] op_sel:[0,1,0] op_sel_hi:[1,1,1]
    v_pk_fma_f32 v[76:77], v[74:75], v[46:47], v[76:77] op_sel:[0,0,0] op_sel_hi:[1,0,1]
    v_pk_fma_f32 v[92:93], v[90:91], v[46:47], v[92:93] op_sel:[0,0,0] op_sel_hi:[1,0,1]
    v_pk_fma_f32 v[76:77], v[90:91], v[46:47], v[76:77] op_sel:[0,1,0] op_sel_hi:[1,1,1] neg_lo:[0,1,0] neg_hi:[0,1,0]
    v_pk_fma_f32 v[92:93], v[74:75], v[46:47], v[92:93] op_sel:[0,1,0] op_sel_hi:[1,1,1]
    v_pk_fma_f32 v[78:79], v[76:77], v[46:47], v[78:79] op_sel:[0,0,0] op_sel_hi:[1,0,1]
    v_pk_fma_f32 v[94:95], v[92:93], v[46:47], v[94:95] op_sel:[0,0,0] op_sel_hi:[1,0,1]
    v_pk_fma_f32 v[78:79], v[92:93], v[46:47], v[78:79] op_sel:[0,1,0] op_sel_hi:[1,1,1] neg_lo:[0,1,0] neg_hi:[0,1,0]
    v_pk_fma_f32 v[94:95], v[76:77], v[46:47], v[94:95] op_sel:[0,1,0] op_sel_hi:[1,1,1]
    v_cvt_pk_bf16_f32 v124, v64, v66
    v_cvt_pk_bf16_f32 v125, v68, v70
    v_cvt_pk_bf16_f32 v126, v72, v74
    v_cvt_pk_bf16_f32 v127, v76, v78
    buffer_store_dwordx4 v[124:127], v8, s[16:19], s54 offen offset:0 sc1
    v_cvt_pk_bf16_f32 v132, -v80, -v82
    v_cvt_pk_bf16_f32 v133, -v84, -v86
    v_cvt_pk_bf16_f32 v134, -v88, -v90
    v_cvt_pk_bf16_f32 v135, -v92, -v94
    buffer_store_dwordx4 v[132:135], v8, s[16:19], s55 offen offset:0 sc1
    v_cvt_pk_bf16_f32 v128, v65, v67
    v_cvt_pk_bf16_f32 v129, v69, v71
    v_cvt_pk_bf16_f32 v130, v73, v75
    v_cvt_pk_bf16_f32 v131, v77, v79
    buffer_store_dwordx4 v[128:131], v8, s[16:19], s54 offen offset:128 sc1
    v_cvt_pk_bf16_f32 v136, -v81, -v83
    v_cvt_pk_bf16_f32 v137, -v85, -v87
    v_cvt_pk_bf16_f32 v138, -v89, -v91
    v_cvt_pk_bf16_f32 v139, -v93, -v95
    buffer_store_dwordx4 v[136:139], v8, s[16:19], s55 offen offset:128 sc1
    s_mov_b32 s70, s71
    s_lshl_b32 s69, s37, 6
    s_lshl_b32 s68, s38, 2
    s_add_u32 s69, s69, s68
    s_add_u32 s69, s69, 0x622000
    s_waitcnt vmcnt(0)
    s_barrier
    s_cmp_eq_u32 s32, 0
    s_cbranch_scc0 L_T_nopub1122
    v_mov_b32 v32, s70
    v_mov_b32 v33, s69
    s_mov_b64 exec, 1
    buffer_store_dword v32, v33, s[16:19], 0 offen sc1
    s_mov_b64 exec, -1
L_T_nopub1122:
    s_add_u32 s51, s3, 6
    s_and_b32 s51, s51, 7
    s_lshl_b32 s51, s51, 7
    s_lshl_b32 s54, s32, 11
    s_add_u32 m0, s54, 98304
    s_nop 0
    buffer_load_dwordx4 v192, s[12:15], s51 offen lds
    s_add_u32 m0, s54, 99328
    s_nop 0
    buffer_load_dwordx4 v193, s[12:15], s51 offen lds
    s_add_u32 s51, s3, 7
    s_and_b32 s51, s51, 7
    s_lshl_b32 s51, s51, 7
    s_lshl_b32 s54, s32, 11
    s_add_u32 m0, s54, 114688
    s_nop 0
    buffer_load_dwordx4 v192, s[12:15], s51 offen lds
    s_add_u32 m0, s54, 115712
    s_nop 0
    buffer_load_dwordx4 v193, s[12:15], s51 offen lds
    s_and_b32 s43, s32, 1
    s_bfe_u32 s44, s32, 0x10001
    s_lshr_b32 s45, s32, 2
    v_lshlrev_b32 v4, 4, v1
    s_and_b32 s46, s32, 3
    s_lshl_b32 s47, s46, 16
    s_lshl_b32 s48, s45, 21
    s_add_u32 s47, s47, s48
    v_add_u32 v4, s47, v4
    s_lshl_b32 s50, s32, 11
    s_lshl_b32 s48, s4, 1
    s_lshl_b32 s49, s4, 4
    s_lshr_b32 s54, s6, 1
    s_lshl_b32 s54, s54, 6
    s_add_u32 s54, s54, 0x622000
    s_lshl_b32 s55, s7, 6
    s_add_u32 s55, s55, 0x622400
    v_and_b32 v29, 7, v1
    v_lshlrev_b32 v29, 2, v29
    v_add_u32 v30, s54, v29
    v_and_b32 v29, 15, v1
    v_lshlrev_b32 v29, 2, v29
    v_add_u32 v31, s55, v29
    s_mov_b32 s10, 0x200000
    s_mov_b32 s11, 0x20000
    s_mov_b32 s22, 0x400000
    s_mov_b32 s23, 0x20000
    v_and_b32 v26, 15, v1
    v_lshrrev_b32 v27, 2, v26
    v_and_b32 v26, 3, v1
    v_lshrrev_b32 v28, 4, v1
    v_and_b32 v29, 1, v28
    v_lshl_add_u32 v26, v29, 2, v26
    v_and_b32 v29, 1, v26
    v_lshlrev_b32 v29, 2, v29
    v_lshrrev_b32 v26, 1, v26
    v_add_u32 v26, v26, v29
    v_lshrrev_b32 v28, 1, v28
    v_lshlrev_b32 v28, 10, v28
    v_and_b32 v29, 1, v26
    v_lshl_add_u32 v28, v29, 3, v28
    v_lshrrev_b32 v29, 1, v26
    v_lshl_add_u32 v28, v29, 7, v28
    v_lshrrev_b32 v29, 2, v26
    v_lshl_add_u32 v27, v29, 2, v27
    v_lshl_add_u32 v28, v27, 4, v28
    s_lshl_b32 s54, s45, 13
    s_lshl_b32 s55, s43, 9
    s_add_u32 s54, s54, s55
    v_add_u32 v8, s54, v28
    v_xor_b32 v7, 64, v8
    v_and_b32 v26, 31, v1
    v_lshrrev_b32 v27, 5, v1
    v_bfe_u32 v28, v26, 1, 3
    v_xor_b32 v28, v28, v27
    v_lshlrev_b32 v28, 4, v28
    v_lshl_add_u32 v28, v26, 7, v28
    s_lshl_b32 s54, s45, 13
    s_lshl_b32 s55, s44, 12
    s_add_u32 s54, s54, s55
    v_add_u32 v9, s54, v28
    v_xor_b32 v10, 32, v9
    v_xor_b32 v11, 64, v9
    v_xor_b32 v12, 96, v9
    v_lshrrev_b32 v26, 5, v1
    v_and_b32 v27, 31, v1
    s_lshl_b32 s54, s43, 5
    s_lshl_b32 s55, s45, 3
    s_add_u32 s54, s54, s55
    v_lshl_add_u32 v26, v26, 4, s54
    s_lshl_b32 s55, s44, 5
    v_add_u32 v27, s55, v27
    v_lshlrev_b32 v47, 2, v26
    v_lshlrev_b32 v28, 2, v27
    v_lshl_add_u32 v15, v26, 11, v28
    v_add_u32 v16, s5, v27
    v_lshlrev_b32 v16, 1, v16
    v_lshlrev_b32 v28, 1, v26
    v_lshl_add_u32 v46, v27, 7, v28
    v_add_u32 v46, 139264, v46
    v_and_b32 v28, 15, v1
    v_lshrrev_b32 v28, 2, v28
    v_add_u32 v28, v28, v26
    v_lshlrev_b32 v28, 7, v28
    v_bfe_u32 v29, v1, 4, 1
    v_lshl_add_u32 v28, v29, 5, v28
    v_and_b32 v29, 3, v1
    v_lshl_add_u32 v28, v29, 3, v28
    s_lshl_b32 s55, s44, 6
    s_add_u32 s55, s55, 131072
    v_add_u32 v45, s55, v28
    v_lshrrev_b32 v28, 3, v1
    s_lshl_b32 s54, s32, 3
    v_add_u32 v28, s54, v28
    v_and_b32 v29, 7, v1
    v_lshlrev_b32 v29, 4, v29
    v_lshl_add_u32 v13, v28, 10, v29
    v_lshl_add_u32 v14, v28, 12, v29
L_TAIL:
    s_lshl_b32 s54, s4, 10
    s_lshl_b32 s55, s5, 1
    s_add_u32 s54, s54, s55
    s_lshl_b32 s55, s32, 10
    s_add_u32 m0, s55, 131072
    s_nop 0
    buffer_load_dwordx4 v13, s[8:11], s54 offen lds
    global_load_ushort v44, v16, s[24:25]
    v_add_u32 v64, 0x10000, v9
    v_add_u32 v65, 0x10000, v10
    v_add_u32 v66, 0x10000, v11
    v_add_u32 v67, 0x10000, v12
    ds_read_b128 v[192:195], v64 offset:0
    ds_read_b128 v[196:199], v65 offset:0
    ds_read_b128 v[200:203], v66 offset:0
    ds_read_b128 v[204:207], v67 offset:0
    ds_read_b128 v[208:211], v64 offset:16384
    ds_read_b128 v[212:215], v65 offset:16384
    ds_read_b128 v[216:219], v66 offset:16384
    ds_read_b128 v[220:223], v67 offset:16384
    s_waitcnt vmcnt(2)
    s_barrier
    ds_read_b128 v[128:131], v9 offset:0
    ds_read_b128 v[132:135], v10 offset:0
    ds_read_b128 v[136:139], v11 offset:0
    ds_read_b128 v[140:143], v12 offset:0
    ds_read_b128 v[144:147], v9 offset:16384
    ds_read_b128 v[148:151], v10 offset:16384
    ds_read_b128 v[152:155], v11 offset:16384
    ds_read_b128 v[156:159], v12 offset:16384
    ds_read_b128 v[160:163], v9 offset:32768
    ds_read_b128 v[164:167], v10 offset:32768
    ds_read_b128 v[168:171], v11 offset:32768
    ds_read_b128 v[172:175], v12 offset:32768
    ds_read_b128 v[176:179], v9 offset:49152
    ds_read_b128 v[180:183], v10 offset:49152
    ds_read_b128 v[184:187], v11 offset:49152
    ds_read_b128 v[188:191], v12 offset:49152
    ds_read_b128 v[224:227], v64 offset:32768
    ds_read_b128 v[228:231], v65 offset:32768
    ds_read_b128 v[232:235], v66 offset:32768
    ds_read_b128 v[236:239], v67 offset:32768
    ds_read_b128 v[240:243], v64 offset:49152
    ds_read_b128 v[244:247], v65 offset:49152
    ds_read_b128 v[248:251], v66 offset:49152
    ds_read_b128 v[252:255], v67 offset:49152
    s_cmp_eq_u32 s32, 0
    s_cbranch_scc0 L_T_nopoll
    s_mov_b32 s55, 0x8000
L_T_poll:
    buffer_load_dword v34, v30, s[16:19], 0 offen sc1
    s_waitcnt vmcnt(0)
    v_cmp_ne_u32 vcc, s70, v34
    s_cbranch_vccz L_T_pok
    s_sub_u32 s55, s55, 1
    s_cmp_lg_u32 s55, 0
    s_cbranch_scc1 L_T_poll
L_T_pok:
    buffer_load_dword v35, v31, s[16:19], 0 offen sc1
L_T_nopoll:
    s_waitcnt lgkmcnt(0)
    s_cmp_eq_u32 s32, 0
    s_cbranch_scc1 L_T_w0
    s_waitcnt vmcnt(0)
L_T_w0:
    s_barrier
    s_lshl_b32 s54, s4, 2
    s_add_u32 s54, s54, 0x620000
    buffer_load_dwordx4 v[36:39], v47, s[16:19], s54 offen
    buffer_load_dwordx4 v[40:43], v47, s[16:19], s54 offen offset:16
    s_add_u32 s51, s3, 0
    s_and_b32 s51, s51, 7
    s_lshl_b32 s52, s51, 18
    s_add_u32 s52, s52, s49
    s_add_u32 s53, s52, 32768
    s_add_u32 m0, s50, 0
    s_nop 0
    buffer_load_dwordx4 v4, s[16:19], s52 offen  lds
    s_add_u32 m0, s50, 1024
    s_nop 0
    buffer_load_dwordx4 v4, s[16:19], s53 offen  lds
    s_add_u32 s51, s3, 1
    s_and_b32 s51, s51, 7
    s_lshl_b32 s52, s51, 18
    s_add_u32 s52, s52, s49
    s_add_u32 s53, s52, 32768
    s_add_u32 m0, s50, 16384
    s_nop 0
    buffer_load_dwordx4 v4, s[16:19], s52 offen  lds
    s_add_u32 m0, s50, 17408
    s_nop 0
    buffer_load_dwordx4 v4, s[16:19], s53 offen  lds
    s_add_u32 s51, s3, 2
    s_and_b32 s51, s51, 7
    s_lshl_b32 s52, s51, 18
    s_add_u32 s52, s52, s49
    s_add_u32 s53, s52, 32768
    s_add_u32 m0, s50, 32768
    s_nop 0
    buffer_load_dwordx4 v4, s[16:19], s52 offen  lds
    s_add_u32 m0, s50, 33792
    s_nop 0
    buffer_load_dwordx4 v4, s[16:19], s53 offen  lds
    s_add_u32 s51, s3, 3
    s_and_b32 s51, s51, 7
    s_lshl_b32 s52, s51, 18
    s_add_u32 s52, s52, s49
    s_add_u32 s53, s52, 32768
    s_add_u32 m0, s50, 49152
    s_nop 0
    buffer_load_dwordx4 v4, s[16:19], s52 offen  lds
    s_add_u32 m0, s50, 50176
    s_nop 0
    buffer_load_dwordx4 v4, s[16:19], s53 offen  lds
    s_add_u32 s51, s3, 4
    s_and_b32 s51, s51, 7
    s_lshl_b32 s52, s51, 18
    s_add_u32 s52, s52, s49
    s_add_u32 s53, s52, 32768
    s_add_u32 m0, s50, 65536
    s_nop 0
    buffer_load_dwordx4 v4, s[16:19], s52 offen  lds
    s_add_u32 m0, s50, 66560
    s_nop 0
    buffer_load_dwordx4 v4, s[16:19], s53 offen  lds
    s_add_u32 s51, s3, 5
    s_and_b32 s51, s51, 7
    s_lshl_b32 s52, s51, 18
    s_add_u32 s52, s52, s49
    s_add_u32 s53, s52, 32768
    s_add_u32 m0, s50, 81920
    s_nop 0
    buffer_load_dwordx4 v4, s[16:19], s52 offen  lds
    s_add_u32 m0, s50, 82944
    s_nop 0
    buffer_load_dwordx4 v4, s[16:19], s53 offen  lds
    s_add_u32 s51, s3, 6
    s_and_b32 s51, s51, 7
    s_lshl_b32 s52, s51, 18
    s_add_u32 s52, s52, s49
    s_add_u32 s53, s52, 32768
    s_add_u32 m0, s50, 98304
    s_nop 0
    buffer_load_dwordx4 v4, s[16:19], s52 offen  lds
    s_add_u32 m0, s50, 99328
    s_nop 0
    buffer_load_dwordx4 v4, s[16:19], s53 offen  lds
    s_add_u32 s51, s3, 7
    s_and_b32 s51, s51, 7
    s_lshl_b32 s52, s51, 18
    s_add_u32 s52, s52, s49
    s_add_u32 s53, s52, 32768
    s_add_u32 m0, s50, 114688
    s_nop 0
    buffer_load_dwordx4 v4, s[16:19], s52 offen  lds
    s_add_u32 m0, s50, 115712
    s_nop 0
    buffer_load_dwordx4 v4, s[16:19], s53 offen  lds
    ds_read_b64_tr_b16 v[26:27], v45
    ds_read_b64_tr_b16 v[28:29], v45 offset:512
    v_lshlrev_b32 v44, 16, v44
    s_waitcnt lgkmcnt(0)
    v_lshlrev_b32 v16, 16, v26
    v_mul_f32 v16, v16, v44
    v_and_b32 v17, 0xffff0000, v26
    v_mul_f32 v17, v17, v44
    v_lshlrev_b32 v18, 16, v27
    v_mul_f32 v18, v18, v44
    v_and_b32 v19, 0xffff0000, v27
    v_mul_f32 v19, v19, v44
    v_lshlrev_b32 v20, 16, v28
    v_mul_f32 v20, v20, v44
    v_and_b32 v21, 0xffff0000, v28
    v_mul_f32 v21, v21, v44
    v_lshlrev_b32 v22, 16, v29
    v_mul_f32 v22, v22, v44
    v_and_b32 v23, 0xffff0000, v29
    v_mul_f32 v23, v23, v44
    s_cmp_eq_u32 s32, 0
    s_cbranch_scc0 L_T_nob2
    s_waitcnt vmcnt(18)
    s_mov_b32 s55, 0x8000
L_T_pollb:
    v_cmp_ne_u32 vcc, s70, v35
    s_cbranch_vccz L_T_nob2
    buffer_load_dword v35, v31, s[16:19], 0 offen sc1
    s_waitcnt vmcnt(0)
    s_sub_u32 s55, s55, 1
    s_cmp_lg_u32 s55, 0
    s_cbranch_scc1 L_T_pollb
L_T_nob2:
    s_waitcnt vmcnt(16)
    v_mul_f32 v16, v16, v36
    v_add_f32 v2, v36, v36
    v_sub_f32 v36, 1.0, v36
    v_mul_f32 v17, v17, v37
    v_add_f32 v3, v37, v37
    v_sub_f32 v37, 1.0, v37
    v_mul_f32 v18, v18, v38
    v_add_f32 v5, v38, v38
    v_sub_f32 v38, 1.0, v38
    v_mul_f32 v19, v19, v39
    v_add_f32 v6, v39, v39
    v_sub_f32 v39, 1.0, v39
    v_mul_f32 v20, v20, v40
    v_add_f32 v24, v40, v40
    v_sub_f32 v40, 1.0, v40
    v_mul_f32 v21, v21, v41
    v_add_f32 v25, v41, v41
    v_sub_f32 v41, 1.0, v41
    v_mul_f32 v22, v22, v42
    v_add_f32 v32, v42, v42
    v_sub_f32 v42, 1.0, v42
    v_mul_f32 v23, v23, v43
    v_add_f32 v33, v43, v43
    v_sub_f32 v43, 1.0, v43
    s_waitcnt vmcnt(12)
    s_barrier
    s_lshl_b32 s54, s5, 12
    s_add_u32 s54, s54, s48
    s_add_u32 s54, s54, 0x400000
    s_lshl_b32 s55, s32, 10
    s_add_u32 m0, s55, 139264
    s_nop 0
    buffer_load_dwordx4 v14, s[16:19], s54 offen  lds
    ds_read_b64_tr_b16 v[64:65], v8 offset:0
    ds_read_b64_tr_b16 v[66:67], v7 offset:0
    ds_read_b64_tr_b16 v[68:69], v8 offset:2048
    ds_read_b64_tr_b16 v[70:71], v7 offset:2048
    ds_read_b64_tr_b16 v[72:73], v8 offset:4096
    ds_read_b64_tr_b16 v[74:75], v7 offset:4096
    ds_read_b64_tr_b16 v[76:77], v8 offset:6144
    ds_read_b64_tr_b16 v[78:79], v7 offset:6144
    ds_read_b64_tr_b16 v[80:81], v8 offset:16384
    ds_read_b64_tr_b16 v[82:83], v7 offset:16384
    ds_read_b64_tr_b16 v[84:85], v8 offset:18432
    ds_read_b64_tr_b16 v[86:87], v7 offset:18432
    ds_read_b64_tr_b16 v[88:89], v8 offset:20480
    ds_read_b64_tr_b16 v[90:91], v7 offset:20480
    ds_read_b64_tr_b16 v[92:93], v8 offset:22528
    ds_read_b64_tr_b16 v[94:95], v7 offset:22528
    s_waitcnt lgkmcnt(0)
    s_waitcnt vmcnt(9)
    s_barrier
    v_mfma_f32_32x32x16_bf16 v[48:63], v[64:67], v[128:131], 0
    ds_read_b64_tr_b16 v[96:97], v8 offset:32768
    ds_read_b64_tr_b16 v[98:99], v7 offset:32768
    ds_read_b64_tr_b16 v[100:101], v8 offset:34816
    v_mfma_f32_32x32x16_bf16 v[48:63], v[68:71], v[132:135], v[48:63]
    ds_read_b64_tr_b16 v[102:103], v7 offset:34816
    ds_read_b64_tr_b16 v[104:105], v8 offset:36864
    v_mfma_f32_32x32x16_bf16 v[48:63], v[72:75], v[136:139], v[48:63]
    ds_read_b64_tr_b16 v[106:107], v7 offset:36864
    ds_read_b64_tr_b16 v[108:109], v8 offset:38912
    v_mfma_f32_32x32x16_bf16 v[48:63], v[76:79], v[140:143], v[48:63]
    ds_read_b64_tr_b16 v[110:111], v7 offset:38912
    ds_read_b64_tr_b16 v[112:113], v8 offset:49152
    ds_read_b64_tr_b16 v[114:115], v7 offset:49152
    v_mfma_f32_32x32x16_bf16 v[48:63], v[80:83], v[144:147], v[48:63]
    ds_read_b64_tr_b16 v[116:117], v8 offset:51200
    ds_read_b64_tr_b16 v[118:119], v7 offset:51200
    v_mfma_f32_32x32x16_bf16 v[48:63], v[84:87], v[148:151], v[48:63]
    ds_read_b64_tr_b16 v[120:121], v8 offset:53248
    ds_read_b64_tr_b16 v[122:123], v7 offset:53248
    v_mfma_f32_32x32x16_bf16 v[48:63], v[88:91], v[152:155], v[48:63]
    ds_read_b64_tr_b16 v[124:125], v8 offset:55296
    ds_read_b64_tr_b16 v[126:127], v7 offset:55296
    v_mfma_f32_32x32x16_bf16 v[48:63], v[92:95], v[156:159], v[48:63]
    s_waitcnt lgkmcnt(0)
    s_waitcnt vmcnt(5)
    s_barrier
    v_xor_b32 v8, 0x10000, v8
    v_xor_b32 v7, 0x10000, v7
    v_mfma_f32_32x32x16_bf16 v[48:63], v[96:99], v[160:163], v[48:63]
    ds_read_b64_tr_b16 v[64:65], v8 offset:0
    ds_read_b64_tr_b16 v[66:67], v7 offset:0
    ds_read_b64_tr_b16 v[68:69], v8 offset:2048
    v_mfma_f32_32x32x16_bf16 v[48:63], v[100:103], v[164:167], v[48:63]
    ds_read_b64_tr_b16 v[70:71], v7 offset:2048
    ds_read_b64_tr_b16 v[72:73], v8 offset:4096
    v_mfma_f32_32x32x16_bf16 v[48:63], v[104:107], v[168:171], v[48:63]
    ds_read_b64_tr_b16 v[74:75], v7 offset:4096
    ds_read_b64_tr_b16 v[76:77], v8 offset:6144
    v_mfma_f32_32x32x16_bf16 v[48:63], v[108:111], v[172:175], v[48:63]
    ds_read_b64_tr_b16 v[78:79], v7 offset:6144
    ds_read_b64_tr_b16 v[80:81], v8 offset:16384
    ds_read_b64_tr_b16 v[82:83], v7 offset:16384
    v_mfma_f32_32x32x16_bf16 v[48:63], v[112:115], v[176:179], v[48:63]
    ds_read_b64_tr_b16 v[84:85], v8 offset:18432
    ds_read_b64_tr_b16 v[86:87], v7 offset:18432
    v_mfma_f32_32x32x16_bf16 v[48:63], v[116:119], v[180:183], v[48:63]
    ds_read_b64_tr_b16 v[88:89], v8 offset:20480
    ds_read_b64_tr_b16 v[90:91], v7 offset:20480
    v_mfma_f32_32x32x16_bf16 v[48:63], v[120:123], v[184:187], v[48:63]
    ds_read_b64_tr_b16 v[92:93], v8 offset:22528
    ds_read_b64_tr_b16 v[94:95], v7 offset:22528
    v_mfma_f32_32x32x16_bf16 v[48:63], v[124:127], v[188:191], v[48:63]
    s_waitcnt lgkmcnt(0)
    s_waitcnt vmcnt(1)
    s_barrier
    v_mfma_f32_32x32x16_bf16 v[48:63], v[64:67], v[192:195], v[48:63]
    ds_read_b64_tr_b16 v[96:97], v8 offset:32768
    ds_read_b64_tr_b16 v[98:99], v7 offset:32768
    ds_read_b64_tr_b16 v[100:101], v8 offset:34816
    v_mfma_f32_32x32x16_bf16 v[48:63], v[68:71], v[196:199], v[48:63]
    ds_read_b64_tr_b16 v[102:103], v7 offset:34816
    ds_read_b64_tr_b16 v[104:105], v8 offset:36864
    v_mfma_f32_32x32x16_bf16 v[48:63], v[72:75], v[200:203], v[48:63]
    ds_read_b64_tr_b16 v[106:107], v7 offset:36864
    ds_read_b64_tr_b16 v[108:109], v8 offset:38912
    v_mfma_f32_32x32x16_bf16 v[48:63], v[76:79], v[204:207], v[48:63]
    ds_read_b64_tr_b16 v[110:111], v7 offset:38912
    ds_read_b64_tr_b16 v[112:113], v8 offset:49152
    ds_read_b64_tr_b16 v[114:115], v7 offset:49152
    v_mfma_f32_32x32x16_bf16 v[48:63], v[80:83], v[208:211], v[48:63]
    ds_read_b64_tr_b16 v[116:117], v8 offset:51200
    ds_read_b64_tr_b16 v[118:119], v7 offset:51200
    v_mfma_f32_32x32x16_bf16 v[48:63], v[84:87], v[212:215], v[48:63]
    ds_read_b64_tr_b16 v[120:121], v8 offset:53248
    ds_read_b64_tr_b16 v[122:123], v7 offset:53248
    v_mfma_f32_32x32x16_bf16 v[48:63], v[88:91], v[216:219], v[48:63]
    ds_read_b64_tr_b16 v[124:125], v8 offset:55296
    ds_read_b64_tr_b16 v[126:127], v7 offset:55296
    v_mfma_f32_32x32x16_bf16 v[48:63], v[92:95], v[220:223], v[48:63]
    s_waitcnt lgkmcnt(0)
    s_waitcnt vmcnt(0)
    s_barrier
    v_lshlrev_b32 v4, 4, v1
    s_lshl_b32 s54, s32, 11
    s_add_u32 s54, s54, 147456
    v_add_u32 v13, s54, v4
    s_xor_b32 s54, s32, 4
    s_lshl_b32 s54, s54, 11
    s_add_u32 s54, s54, 147456
    v_add_u32 v4, s54, v4
    s_lshl_b32 s54, s4, 11
    s_lshl_b32 s55, s5, 2
    s_add_u32 s54, s54, s55
    v_mfma_f32_32x32x16_bf16 v[48:63], v[96:99], v[224:227], v[48:63]
    ds_read_b128 v[26:29], v46
    v_mfma_f32_32x32x16_bf16 v[48:63], v[100:103], v[228:231], v[48:63]
    s_waitcnt lgkmcnt(0)
    v_lshlrev_b32 v64, 16, v26
    v_fmac_f32 v16, v36, v64
    v_and_b32 v65, 0xffff0000, v26
    v_fmac_f32 v17, v37, v65
    v_mfma_f32_32x32x16_bf16 v[48:63], v[104:107], v[232:235], v[48:63]
    v_lshlrev_b32 v64, 16, v27
    v_fmac_f32 v18, v38, v64
    v_mfma_f32_32x32x16_bf16 v[48:63], v[108:111], v[236:239], v[48:63]
    v_and_b32 v65, 0xffff0000, v27
    v_fmac_f32 v19, v39, v65
    v_mfma_f32_32x32x16_bf16 v[48:63], v[112:115], v[240:243], v[48:63]
    v_lshlrev_b32 v64, 16, v28
    v_fmac_f32 v20, v40, v64
    v_and_b32 v65, 0xffff0000, v28
    v_fmac_f32 v21, v41, v65
    v_mfma_f32_32x32x16_bf16 v[48:63], v[116:119], v[244:247], v[48:63]
    v_lshlrev_b32 v64, 16, v29
    v_fmac_f32 v22, v42, v64
    v_mfma_f32_32x32x16_bf16 v[48:63], v[120:123], v[248:251], v[48:63]
    v_and_b32 v65, 0xffff0000, v29
    v_fmac_f32 v23, v43, v65
    v_mfma_f32_32x32x16_bf16 v[48:63], v[124:127], v[252:255], v[48:63]
    s_cmp_eq_u32 s45, 1
    s_cbranch_scc1 L_T_kh1
    s_nop 9
    ds_write_b128 v13, v[56:59]
    ds_write_b128 v13, v[60:63] offset:1024
    v_fmac_f32 v16, v2, v48
    v_fmac_f32 v17, v3, v49
    v_fmac_f32 v18, v5, v50
    v_fmac_f32 v19, v6, v51
    v_fmac_f32 v20, v24, v52
    v_fmac_f32 v21, v25, v53
    v_fmac_f32 v22, v32, v54
    v_fmac_f32 v23, v33, v55
    s_waitcnt lgkmcnt(0)
    s_barrier
    ds_read_b128 v[96:99], v4
    ds_read_b128 v[100:103], v4 offset:1024
    s_waitcnt lgkmcnt(1)
    v_fmac_f32 v16, v2, v96
    buffer_store_dword v16, v15, s[20:23], s54 offen
    s_add_u32 s54, s54, 2048
    v_fmac_f32 v17, v3, v97
    buffer_store_dword v17, v15, s[20:23], s54 offen
    s_add_u32 s54, s54, 2048
    v_fmac_f32 v18, v5, v98
    buffer_store_dword v18, v15, s[20:23], s54 offen
    s_add_u32 s54, s54, 2048
    v_fmac_f32 v19, v6, v99
    buffer_store_dword v19, v15, s[20:23], s54 offen
    s_add_u32 s54, s54, 2048
    s_waitcnt lgkmcnt(0)
    v_fmac_f32 v20, v24, v100
    buffer_store_dword v20, v15, s[20:23], s54 offen
    s_add_u32 s54, s54, 2048
    v_fmac_f32 v21, v25, v101
    buffer_store_dword v21, v15, s[20:23], s54 offen
    s_add_u32 s54, s54, 2048
    v_fmac_f32 v22, v32, v102
    buffer_store_dword v22, v15, s[20:23], s54 offen
    s_add_u32 s54, s54, 2048
    v_fmac_f32 v23, v33, v103
    buffer_store_dword v23, v15, s[20:23], s54 offen
    s_branch L_T_fin
L_T_kh1:
    s_nop 9
    ds_write_b128 v13, v[48:51]
    ds_write_b128 v13, v[52:55] offset:1024
    v_fmac_f32 v16, v2, v56
    v_fmac_f32 v17, v3, v57
    v_fmac_f32 v18, v5, v58
    v_fmac_f32 v19, v6, v59
    v_fmac_f32 v20, v24, v60
    v_fmac_f32 v21, v25, v61
    v_fmac_f32 v22, v32, v62
    v_fmac_f32 v23, v33, v63
    s_waitcnt lgkmcnt(0)
    s_barrier
    ds_read_b128 v[96:99], v4
    ds_read_b128 v[100:103], v4 offset:1024
    s_waitcnt lgkmcnt(1)
    v_fmac_f32 v16, v2, v96
    buffer_store_dword v16, v15, s[20:23], s54 offen
    s_add_u32 s54, s54, 2048
    v_fmac_f32 v17, v3, v97
    buffer_store_dword v17, v15, s[20:23], s54 offen
    s_add_u32 s54, s54, 2048
    v_fmac_f32 v18, v5, v98
    buffer_store_dword v18, v15, s[20:23], s54 offen
    s_add_u32 s54, s54, 2048
    v_fmac_f32 v19, v6, v99
    buffer_store_dword v19, v15, s[20:23], s54 offen
    s_add_u32 s54, s54, 2048
    s_waitcnt lgkmcnt(0)
    v_fmac_f32 v20, v24, v100
    buffer_store_dword v20, v15, s[20:23], s54 offen
    s_add_u32 s54, s54, 2048
    v_fmac_f32 v21, v25, v101
    buffer_store_dword v21, v15, s[20:23], s54 offen
    s_add_u32 s54, s54, 2048
    v_fmac_f32 v22, v32, v102
    buffer_store_dword v22, v15, s[20:23], s54 offen
    s_add_u32 s54, s54, 2048
    v_fmac_f32 v23, v33, v103
    buffer_store_dword v23, v15, s[20:23], s54 offen
L_T_fin:
L_F_end:
    s_endpgm
L_B_rest:
    s_waitcnt vmcnt(2)
    s_load_dwordx4 s[28:31], s[0:1], 40
    v_lshlrev_b32 v8, 16, v8
    v_lshlrev_b32 v12, 16, v12
    v_mul_f32 v8, 0x3fb8aa3b, v8
    v_mul_f32 v12, 0x3fb8aa3b, v12
    v_exp_f32 v8, v8
    v_exp_f32 v12, v12
    v_lshlrev_b32 v9, 16, v9
    v_lshlrev_b32 v10, 16, v10
    v_lshlrev_b32 v11, 16, v11
    v_lshlrev_b32 v13, 16, v13
    v_cvt_pk_bf16_f32 v8, v8, v8
    v_and_b32 v8, 0xffff0000, v8
    v_cvt_pk_bf16_f32 v12, v12, v12
    v_and_b32 v12, 0xffff0000, v12
    v_mul_f32 v32, v8, v12
    v_mul_f32 v33, v9, v12
    v_mul_f32 v32, 0xbfb8aa3b, v32
    v_mul_f32 v33, 0x3e22f983, v33
    v_add_f32 v12, v12, v12
    v_mul_f32 v34, v10, v12
    v_mul_f32 v35, v11, v12
    v_mul_f32 v36, 0x41000000, v32
    v_mul_f32 v37, 0x41000000, v33
    v_exp_f32 v36, v36
    v_fract_f32 v37, v37
    v_cos_f32 v46, v37
    v_sin_f32 v47, v37
    v_mul_f32 v46, v46, v36
    v_mul_f32 v47, v47, v36
    v_mul_f32 v36, 0x43000000, v32
    v_mul_f32 v37, 0x43000000, v33
    v_exp_f32 v36, v36
    v_fract_f32 v37, v37
    v_cos_f32 v48, v37
    v_sin_f32 v49, v37
    v_mul_f32 v48, v48, v36
    v_mul_f32 v49, v49, v36
    v_exp_f32 v36, v32
    v_fract_f32 v37, v33
    v_cos_f32 v40, v37
    v_sin_f32 v41, v37
    v_mul_f32 v40, v40, v36
    v_mul_f32 v41, v41, v36
    v_pk_mul_f32 v[42:43], v[40:41], v[40:41] op_sel:[1,1] op_sel_hi:[1,0] neg_lo:[0,1]
    v_pk_fma_f32 v[42:43], v[40:41], v[40:41], v[42:43] op_sel_hi:[0,1,1]
    v_pk_mul_f32 v[44:45], v[42:43], v[42:43] op_sel:[1,1] op_sel_hi:[1,0] neg_lo:[0,1]
    v_pk_fma_f32 v[44:45], v[42:43], v[42:43], v[44:45] op_sel_hi:[0,1,1]
    v_mov_b32 v56, 0x3f80
    ds_write_b32 v24, v56 offset:28672
    v_cvt_pk_bf16_f32 v57, v46, -v47
    ds_write_b32 v25, v57 offset:29184
    v_cvt_pk_bf16_f32 v58, v34, v35
    ds_write_b32 v24, v58 offset:0
    v_pk_mul_f32 v[64:65], v[34:35], v[40:41] op_sel:[1,1] op_sel_hi:[1,0] neg_lo:[0,1]
    v_pk_fma_f32 v[64:65], v[34:35], v[40:41], v[64:65] op_sel_hi:[0,1,1]
    v_cvt_pk_bf16_f32 v59, v64, v65
    ds_write_b32 v25, v59 offset:512
    v_pk_mul_f32 v[66:67], v[64:65], v[40:41] op_sel:[1,1] op_sel_hi:[1,0] neg_lo:[0,1]
    v_pk_fma_f32 v[66:67], v[64:65], v[40:41], v[66:67] op_sel_hi:[0,1,1]
    v_cvt_pk_bf16_f32 v56, v66, v67
    ds_write_b32 v26, v56 offset:1024
    v_pk_mul_f32 v[64:65], v[66:67], v[40:41] op_sel:[1,1] op_sel_hi:[1,0] neg_lo:[0,1]
    v_pk_fma_f32 v[64:65], v[66:67], v[40:41], v[64:65] op_sel_hi:[0,1,1]
    v_cvt_pk_bf16_f32 v57, v64, v65
    ds_write_b32 v27, v57 offset:1536
    v_pk_mul_f32 v[66:67], v[64:65], v[40:41] op_sel:[1,1] op_sel_hi:[1,0] neg_lo:[0,1]
    v_pk_fma_f32 v[66:67], v[64:65], v[40:41], v[66:67] op_sel_hi:[0,1,1]
    v_cvt_pk_bf16_f32 v58, v66, v67
    ds_write_b32 v28, v58 offset:2048
    v_pk_mul_f32 v[64:65], v[66:67], v[40:41] op_sel:[1,1] op_sel_hi:[1,0] neg_lo:[0,1]
    v_pk_fma_f32 v[64:65], v[66:67], v[40:41], v[64:65] op_sel_hi:[0,1,1]
    v_cvt_pk_bf16_f32 v59, v64, v65
    ds_write_b32 v29, v59 offset:2560
    v_pk_mul_f32 v[66:67], v[64:65], v[40:41] op_sel:[1,1] op_sel_hi:[1,0] neg_lo:[0,1]
    v_pk_fma_f32 v[66:67], v[64:65], v[40:41], v[66:67] op_sel_hi:[0,1,1]
    v_cvt_pk_bf16_f32 v56, v66, v67
    ds_write_b32 v30, v56 offset:3072
    v_pk_mul_f32 v[64:65], v[66:67], v[40:41] op_sel:[1,1] op_sel_hi:[1,0] neg_lo:[0,1]
    v_pk_fma_f32 v[64:65], v[66:67], v[40:41], v[64:65] op_sel_hi:[0,1,1]
    v_cvt_pk_bf16_f32 v57, v64, v65
    ds_write_b32 v31, v57 offset:3584
    v_pk_mul_f32 v[60:61], v[46:47], v[46:47] op_sel:[1,1] op_sel_hi:[1,0] neg_lo:[0,1]
    v_pk_fma_f32 v[60:61], v[46:47], v[46:47], v[60:61] op_sel_hi:[0,1,1]
    v_cvt_pk_bf16_f32 v58, v60, -v61
    ds_write_b32 v26, v58 offset:29696
    v_pk_mul_f32 v[38:39], v[34:35], v[48:49] op_sel:[1,1] op_sel_hi:[1,0] neg_lo:[0,1]
    v_pk_fma_f32 v[38:39], v[34:35], v[48:49], v[38:39] op_sel_hi:[0,1,1]
    v_cvt_pk_bf16_f32 v59, v38, v39
    ds_write_b32 v24, v59 offset:4096
    v_pk_mul_f32 v[64:65], v[38:39], v[40:41] op_sel:[1,1] op_sel_hi:[1,0] neg_lo:[0,1]
    v_pk_fma_f32 v[64:65], v[38:39], v[40:41], v[64:65] op_sel_hi:[0,1,1]
    v_cvt_pk_bf16_f32 v56, v64, v65
    ds_write_b32 v25, v56 offset:4608
    v_pk_mul_f32 v[66:67], v[64:65], v[40:41] op_sel:[1,1] op_sel_hi:[1,0] neg_lo:[0,1]
    v_pk_fma_f32 v[66:67], v[64:65], v[40:41], v[66:67] op_sel_hi:[0,1,1]
    v_cvt_pk_bf16_f32 v57, v66, v67
    ds_write_b32 v26, v57 offset:5120
    v_pk_mul_f32 v[64:65], v[66:67], v[40:41] op_sel:[1,1] op_sel_hi:[1,0] neg_lo:[0,1]
    v_pk_fma_f32 v[64:65], v[66:67], v[40:41], v[64:65] op_sel_hi:[0,1,1]
    v_cvt_pk_bf16_f32 v58, v64, v65
    ds_write_b32 v27, v58 offset:5632
    v_pk_mul_f32 v[66:67], v[64:65], v[40:41] op_sel:[1,1] op_sel_hi:[1,0] neg_lo:[0,1]
    v_pk_fma_f32 v[66:67], v[64:65], v[40:41], v[66:67] op_sel_hi:[0,1,1]
    v_cvt_pk_bf16_f32 v59, v66, v67
    ds_write_b32 v28, v59 offset:6144
    v_pk_mul_f32 v[64:65], v[66:67], v[40:41] op_sel:[1,1] op_sel_hi:[1,0] neg_lo:[0,1]
    v_pk_fma_f32 v[64:65], v[66:67], v[40:41], v[64:65] op_sel_hi:[0,1,1]
    v_cvt_pk_bf16_f32 v56, v64, v65
    ds_write_b32 v29, v56 offset:6656
    v_pk_mul_f32 v[66:67], v[64:65], v[40:41] op_sel:[1,1] op_sel_hi:[1,0] neg_lo:[0,1]
    v_pk_fma_f32 v[66:67], v[64:65], v[40:41], v[66:67] op_sel_hi:[0,1,1]
    v_cvt_pk_bf16_f32 v57, v66, v67
    ds_write_b32 v30, v57 offset:7168
    v_pk_mul_f32 v[64:65], v[66:67], v[40:41] op_sel:[1,1] op_sel_hi:[1,0] neg_lo:[0,1]
    v_pk_fma_f32 v[64:65], v[66:67], v[40:41], v[64:65] op_sel_hi:[0,1,1]
    v_cvt_pk_bf16_f32 v58, v64, v65
    ds_write_b32 v31, v58 offset:7680
    v_pk_mul_f32 v[62:63], v[60:61], v[46:47] op_sel:[1,1] op_sel_hi:[1,0] neg_lo:[0,1]
    v_pk_fma_f32 v[62:63], v[60:61], v[46:47], v[62:63] op_sel_hi:[0,1,1]
    v_cvt_pk_bf16_f32 v59, v62, -v63
    ds_write_b32 v27, v59 offset:30208
    v_pk_mul_f32 v[34:35], v[38:39], v[48:49] op_sel:[1,1] op_sel_hi:[1,0] neg_lo:[0,1]
    v_pk_fma_f32 v[34:35], v[38:39], v[48:49], v[34:35] op_sel_hi:[0,1,1]
    v_cvt_pk_bf16_f32 v56, v34, v35
    ds_write_b32 v24, v56 offset:24576
    v_pk_mul_f32 v[64:65], v[34:35], v[42:43] op_sel:[1,1] op_sel_hi:[1,0] neg_lo:[0,1]
    v_pk_fma_f32 v[64:65], v[34:35], v[42:43], v[64:65] op_sel_hi:[0,1,1]
    v_cvt_pk_bf16_f32 v57, v64, v65
    ds_write_b32 v25, v57 offset:25088
    v_pk_mul_f32 v[66:67], v[64:65], v[42:43] op_sel:[1,1] op_sel_hi:[1,0] neg_lo:[0,1]
    v_pk_fma_f32 v[66:67], v[64:65], v[42:43], v[66:67] op_sel_hi:[0,1,1]
    v_cvt_pk_bf16_f32 v58, v66, v67
    ds_write_b32 v26, v58 offset:25600
    v_pk_mul_f32 v[64:65], v[66:67], v[42:43] op_sel:[1,1] op_sel_hi:[1,0] neg_lo:[0,1]
    v_pk_fma_f32 v[64:65], v[66:67], v[42:43], v[64:65] op_sel_hi:[0,1,1]
    v_cvt_pk_bf16_f32 v59, v64, v65
    ds_write_b32 v27, v59 offset:26112
    v_pk_mul_f32 v[66:67], v[64:65], v[42:43] op_sel:[1,1] op_sel_hi:[1,0] neg_lo:[0,1]
    v_pk_fma_f32 v[66:67], v[64:65], v[42:43], v[66:67] op_sel_hi:[0,1,1]
    v_cvt_pk_bf16_f32 v56, v66, v67
    ds_write_b32 v27, v56 offset:17920
    v_pk_mul_f32 v[60:61], v[62:63], v[46:47] op_sel:[1,1] op_sel_hi:[1,0] neg_lo:[0,1]
    v_pk_fma_f32 v[60:61], v[62:63], v[46:47], v[60:61] op_sel_hi:[0,1,1]
    v_cvt_pk_bf16_f32 v57, v60, -v61
    ds_write_b32 v28, v57 offset:30720
    v_pk_mul_f32 v[38:39], v[34:35], v[48:49] op_sel:[1,1] op_sel_hi:[1,0] neg_lo:[0,1]
    v_pk_fma_f32 v[38:39], v[34:35], v[48:49], v[38:39] op_sel_hi:[0,1,1]
    v_cvt_pk_bf16_f32 v58, v38, v39
    ds_write_b32 v28, v58 offset:26624
    v_pk_mul_f32 v[64:65], v[38:39], v[42:43] op_sel:[1,1] op_sel_hi:[1,0] neg_lo:[0,1]
    v_pk_fma_f32 v[64:65], v[38:39], v[42:43], v[64:65] op_sel_hi:[0,1,1]
    v_cvt_pk_bf16_f32 v59, v64, v65
    ds_write_b32 v29, v59 offset:27136
    v_pk_mul_f32 v[66:67], v[64:65], v[42:43] op_sel:[1,1] op_sel_hi:[1,0] neg_lo:[0,1]
    v_pk_fma_f32 v[66:67], v[64:65], v[42:43], v[66:67] op_sel_hi:[0,1,1]
    v_cvt_pk_bf16_f32 v56, v66, v67
    ds_write_b32 v30, v56 offset:27648
    v_pk_mul_f32 v[64:65], v[66:67], v[42:43] op_sel:[1,1] op_sel_hi:[1,0] neg_lo:[0,1]
    v_pk_fma_f32 v[64:65], v[66:67], v[42:43], v[64:65] op_sel_hi:[0,1,1]
    v_cvt_pk_bf16_f32 v57, v64, v65
    ds_write_b32 v31, v57 offset:28160
    v_pk_mul_f32 v[66:67], v[64:65], v[42:43] op_sel:[1,1] op_sel_hi:[1,0] neg_lo:[0,1]
    v_pk_fma_f32 v[66:67], v[64:65], v[42:43], v[66:67] op_sel_hi:[0,1,1]
    v_cvt_pk_bf16_f32 v58, v66, v67
    ds_write_b32 v31, v58 offset:19968
    v_pk_mul_f32 v[62:63], v[60:61], v[46:47] op_sel:[1,1] op_sel_hi:[1,0] neg_lo:[0,1]
    v_pk_fma_f32 v[62:63], v[60:61], v[46:47], v[62:63] op_sel_hi:[0,1,1]
    v_cvt_pk_bf16_f32 v59, v62, -v63
    ds_write_b32 v29, v59 offset:31232
    v_pk_mul_f32 v[34:35], v[38:39], v[48:49] op_sel:[1,1] op_sel_hi:[1,0] neg_lo:[0,1]
    v_pk_fma_f32 v[34:35], v[38:39], v[48:49], v[34:35] op_sel_hi:[0,1,1]
    v_cvt_pk_bf16_f32 v56, v34, v35
    ds_write_b32 v24, v56 offset:16384
    v_pk_mul_f32 v[64:65], v[34:35], v[44:45] op_sel:[1,1] op_sel_hi:[1,0] neg_lo:[0,1]
    v_pk_fma_f32 v[64:65], v[34:35], v[44:45], v[64:65] op_sel_hi:[0,1,1]
    v_cvt_pk_bf16_f32 v57, v64, v65
    ds_write_b32 v25, v57 offset:16896
    v_pk_mul_f32 v[66:67], v[64:65], v[44:45] op_sel:[1,1] op_sel_hi:[1,0] neg_lo:[0,1]
    v_pk_fma_f32 v[66:67], v[64:65], v[44:45], v[66:67] op_sel_hi:[0,1,1]
    v_cvt_pk_bf16_f32 v58, v66, v67
    ds_write_b32 v26, v58 offset:17408
    v_pk_mul_f32 v[60:61], v[62:63], v[46:47] op_sel:[1,1] op_sel_hi:[1,0] neg_lo:[0,1]
    v_pk_fma_f32 v[60:61], v[62:63], v[46:47], v[60:61] op_sel_hi:[0,1,1]
    v_cvt_pk_bf16_f32 v59, v60, -v61
    ds_write_b32 v30, v59 offset:31744
    v_pk_mul_f32 v[38:39], v[34:35], v[48:49] op_sel:[1,1] op_sel_hi:[1,0] neg_lo:[0,1]
    v_pk_fma_f32 v[38:39], v[34:35], v[48:49], v[38:39] op_sel_hi:[0,1,1]
    v_cvt_pk_bf16_f32 v56, v38, v39
    ds_write_b32 v28, v56 offset:18432
    v_pk_mul_f32 v[64:65], v[38:39], v[44:45] op_sel:[1,1] op_sel_hi:[1,0] neg_lo:[0,1]
    v_pk_fma_f32 v[64:65], v[38:39], v[44:45], v[64:65] op_sel_hi:[0,1,1]
    v_cvt_pk_bf16_f32 v57, v64, v65
    ds_write_b32 v29, v57 offset:18944
    v_pk_mul_f32 v[66:67], v[64:65], v[44:45] op_sel:[1,1] op_sel_hi:[1,0] neg_lo:[0,1]
    v_pk_fma_f32 v[66:67], v[64:65], v[44:45], v[66:67] op_sel_hi:[0,1,1]
    v_cvt_pk_bf16_f32 v58, v66, v67
    ds_write_b32 v30, v58 offset:19456
    v_pk_mul_f32 v[62:63], v[60:61], v[46:47] op_sel:[1,1] op_sel_hi:[1,0] neg_lo:[0,1]
    v_pk_fma_f32 v[62:63], v[60:61], v[46:47], v[62:63] op_sel_hi:[0,1,1]
    v_cvt_pk_bf16_f32 v59, v62, -v63
    ds_write_b32 v31, v59 offset:32256
    v_pk_mul_f32 v[34:35], v[38:39], v[48:49] op_sel:[1,1] op_sel_hi:[1,0] neg_lo:[0,1]
    v_pk_fma_f32 v[34:35], v[38:39], v[48:49], v[34:35] op_sel_hi:[0,1,1]
    v_cvt_pk_bf16_f32 v56, v34, v35
    ds_write_b32 v24, v56 offset:20480
    v_pk_mul_f32 v[64:65], v[34:35], v[44:45] op_sel:[1,1] op_sel_hi:[1,0] neg_lo:[0,1]
    v_pk_fma_f32 v[64:65], v[34:35], v[44:45], v[64:65] op_sel_hi:[0,1,1]
    v_cvt_pk_bf16_f32 v57, v64, v65
    ds_write_b32 v25, v57 offset:20992
    v_pk_mul_f32 v[66:67], v[64:65], v[44:45] op_sel:[1,1] op_sel_hi:[1,0] neg_lo:[0,1]
    v_pk_fma_f32 v[66:67], v[64:65], v[44:45], v[66:67] op_sel_hi:[0,1,1]
    v_cvt_pk_bf16_f32 v58, v66, v67
    ds_write_b32 v26, v58 offset:21504
    v_pk_mul_f32 v[60:61], v[62:63], v[46:47] op_sel:[1,1] op_sel_hi:[1,0] neg_lo:[0,1]
    v_pk_fma_f32 v[60:61], v[62:63], v[46:47], v[60:61] op_sel_hi:[0,1,1]
    v_cvt_pk_bf16_f32 v59, v60, -v61
    ds_write_b32 v24, v59 offset:32768
    v_pk_mul_f32 v[38:39], v[34:35], v[48:49] op_sel:[1,1] op_sel_hi:[1,0] neg_lo:[0,1]
    v_pk_fma_f32 v[38:39], v[34:35], v[48:49], v[38:39] op_sel_hi:[0,1,1]
    v_cvt_pk_bf16_f32 v56, v38, v39
    ds_write_b32 v28, v56 offset:22528
    v_pk_mul_f32 v[64:65], v[38:39], v[44:45] op_sel:[1,1] op_sel_hi:[1,0] neg_lo:[0,1]
    v_pk_fma_f32 v[64:65], v[38:39], v[44:45], v[64:65] op_sel_hi:[0,1,1]
    v_cvt_pk_bf16_f32 v57, v64, v65
    ds_write_b32 v29, v57 offset:23040
    v_pk_mul_f32 v[66:67], v[64:65], v[44:45] op_sel:[1,1] op_sel_hi:[1,0] neg_lo:[0,1]
    v_pk_fma_f32 v[66:67], v[64:65], v[44:45], v[66:67] op_sel_hi:[0,1,1]
    v_cvt_pk_bf16_f32 v58, v66, v67
    ds_write_b32 v30, v58 offset:23552
    v_pk_mul_f32 v[62:63], v[60:61], v[46:47] op_sel:[1,1] op_sel_hi:[1,0] neg_lo:[0,1]
    v_pk_fma_f32 v[62:63], v[60:61], v[46:47], v[62:63] op_sel_hi:[0,1,1]
    v_cvt_pk_bf16_f32 v59, v62, -v63
    ds_write_b32 v25, v59 offset:33280
    v_pk_mul_f32 v[34:35], v[38:39], v[48:49] op_sel:[1,1] op_sel_hi:[1,0] neg_lo:[0,1]
    v_pk_fma_f32 v[34:35], v[38:39], v[48:49], v[34:35] op_sel_hi:[0,1,1]
    v_cvt_pk_bf16_f32 v56, v34, v35
    ds_write_b32 v24, v56 offset:8192
    v_pk_mul_f32 v[64:65], v[34:35], v[46:47] op_sel:[1,1] op_sel_hi:[1,0] neg_lo:[0,1]
    v_pk_fma_f32 v[64:65], v[34:35], v[46:47], v[64:65] op_sel_hi:[0,1,1]
    v_cvt_pk_bf16_f32 v57, v64, v65
    ds_write_b32 v25, v57 offset:8704
    v_pk_mul_f32 v[60:61], v[62:63], v[46:47] op_sel:[1,1] op_sel_hi:[1,0] neg_lo:[0,1]
    v_pk_fma_f32 v[60:61], v[62:63], v[46:47], v[60:61] op_sel_hi:[0,1,1]
    v_cvt_pk_bf16_f32 v58, v60, -v61
    ds_write_b32 v26, v58 offset:33792
    v_pk_mul_f32 v[38:39], v[34:35], v[48:49] op_sel:[1,1] op_sel_hi:[1,0] neg_lo:[0,1]
    v_pk_fma_f32 v[38:39], v[34:35], v[48:49], v[38:39] op_sel_hi:[0,1,1]
    v_cvt_pk_bf16_f32 v59, v38, v39
    ds_write_b32 v26, v59 offset:9216
    v_pk_mul_f32 v[64:65], v[38:39], v[46:47] op_sel:[1,1] op_sel_hi:[1,0] neg_lo:[0,1]
    v_pk_fma_f32 v[64:65], v[38:39], v[46:47], v[64:65] op_sel_hi:[0,1,1]
    v_cvt_pk_bf16_f32 v56, v64, v65
    ds_write_b32 v27, v56 offset:9728
    v_pk_mul_f32 v[62:63], v[60:61], v[46:47] op_sel:[1,1] op_sel_hi:[1,0] neg_lo:[0,1]
    v_pk_fma_f32 v[62:63], v[60:61], v[46:47], v[62:63] op_sel_hi:[0,1,1]
    v_cvt_pk_bf16_f32 v57, v62, -v63
    ds_write_b32 v27, v57 offset:34304
    v_pk_mul_f32 v[34:35], v[38:39], v[48:49] op_sel:[1,1] op_sel_hi:[1,0] neg_lo:[0,1]
    v_pk_fma_f32 v[34:35], v[38:39], v[48:49], v[34:35] op_sel_hi:[0,1,1]
    v_cvt_pk_bf16_f32 v58, v34, v35
    ds_write_b32 v28, v58 offset:10240
    v_pk_mul_f32 v[64:65], v[34:35], v[46:47] op_sel:[1,1] op_sel_hi:[1,0] neg_lo:[0,1]
    v_pk_fma_f32 v[64:65], v[34:35], v[46:47], v[64:65] op_sel_hi:[0,1,1]
    v_cvt_pk_bf16_f32 v59, v64, v65
    ds_write_b32 v29, v59 offset:10752
    v_pk_mul_f32 v[60:61], v[62:63], v[46:47] op_sel:[1,1] op_sel_hi:[1,0] neg_lo:[0,1]
    v_pk_fma_f32 v[60:61], v[62:63], v[46:47], v[60:61] op_sel_hi:[0,1,1]
    v_cvt_pk_bf16_f32 v56, v60, -v61
    ds_write_b32 v28, v56 offset:34816
    v_pk_mul_f32 v[38:39], v[34:35], v[48:49] op_sel:[1,1] op_sel_hi:[1,0] neg_lo:[0,1]
    v_pk_fma_f32 v[38:39], v[34:35], v[48:49], v[38:39] op_sel_hi:[0,1,1]
    v_cvt_pk_bf16_f32 v57, v38, v39
    ds_write_b32 v30, v57 offset:11264
    v_pk_mul_f32 v[64:65], v[38:39], v[46:47] op_sel:[1,1] op_sel_hi:[1,0] neg_lo:[0,1]
    v_pk_fma_f32 v[64:65], v[38:39], v[46:47], v[64:65] op_sel_hi:[0,1,1]
    v_cvt_pk_bf16_f32 v58, v64, v65
    ds_write_b32 v31, v58 offset:11776
    v_pk_mul_f32 v[62:63], v[60:61], v[46:47] op_sel:[1,1] op_sel_hi:[1,0] neg_lo:[0,1]
    v_pk_fma_f32 v[62:63], v[60:61], v[46:47], v[62:63] op_sel_hi:[0,1,1]
    v_cvt_pk_bf16_f32 v59, v62, -v63
    ds_write_b32 v29, v59 offset:35328
    v_pk_mul_f32 v[34:35], v[38:39], v[48:49] op_sel:[1,1] op_sel_hi:[1,0] neg_lo:[0,1]
    v_pk_fma_f32 v[34:35], v[38:39], v[48:49], v[34:35] op_sel_hi:[0,1,1]
    v_cvt_pk_bf16_f32 v56, v34, v35
    ds_write_b32 v24, v56 offset:12288
    v_pk_mul_f32 v[64:65], v[34:35], v[46:47] op_sel:[1,1] op_sel_hi:[1,0] neg_lo:[0,1]
    v_pk_fma_f32 v[64:65], v[34:35], v[46:47], v[64:65] op_sel_hi:[0,1,1]
    v_cvt_pk_bf16_f32 v57, v64, v65
    ds_write_b32 v25, v57 offset:12800
    v_pk_mul_f32 v[60:61], v[62:63], v[46:47] op_sel:[1,1] op_sel_hi:[1,0] neg_lo:[0,1]
    v_pk_fma_f32 v[60:61], v[62:63], v[46:47], v[60:61] op_sel_hi:[0,1,1]
    v_cvt_pk_bf16_f32 v58, v60, -v61
    ds_write_b32 v30, v58 offset:35840
    v_pk_mul_f32 v[38:39], v[34:35], v[48:49] op_sel:[1,1] op_sel_hi:[1,0] neg_lo:[0,1]
    v_pk_fma_f32 v[38:39], v[34:35], v[48:49], v[38:39] op_sel_hi:[0,1,1]
    v_cvt_pk_bf16_f32 v59, v38, v39
    ds_write_b32 v26, v59 offset:13312
    v_pk_mul_f32 v[64:65], v[38:39], v[46:47] op_sel:[1,1] op_sel_hi:[1,0] neg_lo:[0,1]
    v_pk_fma_f32 v[64:65], v[38:39], v[46:47], v[64:65] op_sel_hi:[0,1,1]
    v_cvt_pk_bf16_f32 v56, v64, v65
    ds_write_b32 v27, v56 offset:13824
    v_pk_mul_f32 v[62:63], v[60:61], v[46:47] op_sel:[1,1] op_sel_hi:[1,0] neg_lo:[0,1]
    v_pk_fma_f32 v[62:63], v[60:61], v[46:47], v[62:63] op_sel_hi:[0,1,1]
    v_cvt_pk_bf16_f32 v57, v62, -v63
    ds_write_b32 v31, v57 offset:36352
    v_pk_mul_f32 v[34:35], v[38:39], v[48:49] op_sel:[1,1] op_sel_hi:[1,0] neg_lo:[0,1]
    v_pk_fma_f32 v[34:35], v[38:39], v[48:49], v[34:35] op_sel_hi:[0,1,1]
    v_cvt_pk_bf16_f32 v58, v34, v35
    ds_write_b32 v28, v58 offset:14336
    v_pk_mul_f32 v[64:65], v[34:35], v[46:47] op_sel:[1,1] op_sel_hi:[1,0] neg_lo:[0,1]
    v_pk_fma_f32 v[64:65], v[34:35], v[46:47], v[64:65] op_sel_hi:[0,1,1]
    v_cvt_pk_bf16_f32 v59, v64, v65
    ds_write_b32 v29, v59 offset:14848
    v_pk_mul_f32 v[38:39], v[34:35], v[48:49] op_sel:[1,1] op_sel_hi:[1,0] neg_lo:[0,1]
    v_pk_fma_f32 v[38:39], v[34:35], v[48:49], v[38:39] op_sel_hi:[0,1,1]
    v_cvt_pk_bf16_f32 v56, v38, v39
    ds_write_b32 v30, v56 offset:15360
    v_pk_mul_f32 v[64:65], v[38:39], v[46:47] op_sel:[1,1] op_sel_hi:[1,0] neg_lo:[0,1]
    v_pk_fma_f32 v[64:65], v[38:39], v[46:47], v[64:65] op_sel_hi:[0,1,1]
    v_cvt_pk_bf16_f32 v57, v64, v65
    ds_write_b32 v31, v57 offset:15872
    buffer_load_dwordx2 v[18:19], v7, s[8:11], s44 offen offset:1024
    v_and_b32 v2, 15, v1
    v_lshrrev_b32 v3, 4, v1
    v_and_b32 v4, 7, v2
    v_lshlrev_b32 v4, 1, v4
    v_xor_b32 v4, v4, v3
    v_lshlrev_b32 v4, 4, v4
    v_lshl_add_u32 v4, v2, 9, v4
    v_add_u32 v4, s45, v4
    s_lshl_b32 s46, s38, 8
    v_xor_b32 v4, s46, v4
    v_xor_b32 v40, 0, v4
    v_xor_b32 v41, 64, v4
    v_xor_b32 v42, 128, v4
    v_xor_b32 v43, 192, v4
    s_waitcnt lgkmcnt(0)
    s_barrier
    buffer_load_dwordx2 v[20:21], v7, s[8:11], s44 offen offset:2048
    ds_read_b128 v[64:67], v40 offset:28672
    ds_read_b128 v[80:83], v40 offset:0
    ds_read_b128 v[84:87], v40 offset:8192
    ds_read_b128 v[88:91], v40 offset:16384
    ds_read_b128 v[92:95], v40 offset:24576
    ds_read_b128 v[68:71], v41 offset:28672
    ds_read_b128 v[96:99], v41 offset:0
    ds_read_b128 v[100:103], v41 offset:8192
    ds_read_b128 v[104:107], v41 offset:16384
    ds_read_b128 v[108:111], v41 offset:24576
    ds_read_b128 v[72:75], v42 offset:28672
    ds_read_b128 v[112:115], v42 offset:0
    ds_read_b128 v[116:119], v42 offset:8192
    ds_read_b128 v[120:123], v42 offset:16384
    ds_read_b128 v[124:127], v42 offset:24576
    ds_read_b128 v[76:79], v43 offset:28672
    ds_read_b128 v[128:131], v43 offset:0
    ds_read_b128 v[132:135], v43 offset:8192
    ds_read_b128 v[136:139], v43 offset:16384
    ds_read_b128 v[140:143], v43 offset:24576
    v_mov_b32 v44, 0
    v_mov_b32 v45, 0
    v_mov_b32 v46, 0
    v_mov_b32 v47, 0
    v_mov_b32 v48, 0
    v_mov_b32 v49, 0
    v_mov_b32 v50, 0
    v_mov_b32 v51, 0
    v_mov_b32 v52, 0
    v_mov_b32 v53, 0
    v_mov_b32 v54, 0
    v_mov_b32 v55, 0
    v_mov_b32 v56, 0
    v_mov_b32 v57, 0
    v_mov_b32 v58, 0
    v_mov_b32 v59, 0
    s_lshl_b32 s46, s32, 11
    s_add_u32 s46, s46, 147456
    v_lshlrev_b32 v4, 4, v1
    v_add_u32 v5, s46, v4
    s_xor_b32 s46, s46, 2048
    v_add_u32 v4, s46, v4
    s_waitcnt lgkmcnt(15)
    v_mfma_f32_16x16x32_bf16 v[44:47], v[80:83], v[64:67], v[44:47]
    v_mfma_f32_16x16x32_bf16 v[48:51], v[84:87], v[64:67], v[48:51]
    v_mfma_f32_16x16x32_bf16 v[52:55], v[88:91], v[64:67], v[52:55]
    v_mfma_f32_16x16x32_bf16 v[56:59], v[92:95], v[64:67], v[56:59]
    s_waitcnt lgkmcnt(10)
    v_mfma_f32_16x16x32_bf16 v[44:47], v[96:99], v[68:71], v[44:47]
    v_mfma_f32_16x16x32_bf16 v[48:51], v[100:103], v[68:71], v[48:51]
    v_mfma_f32_16x16x32_bf16 v[52:55], v[104:107], v[68:71], v[52:55]
    v_mfma_f32_16x16x32_bf16 v[56:59], v[108:111], v[68:71], v[56:59]
    s_waitcnt lgkmcnt(5)
    v_mfma_f32_16x16x32_bf16 v[44:47], v[112:115], v[72:75], v[44:47]
    v_mfma_f32_16x16x32_bf16 v[48:51], v[116:119], v[72:75], v[48:51]
    v_mfma_f32_16x16x32_bf16 v[52:55], v[120:123], v[72:75], v[52:55]
    v_mfma_f32_16x16x32_bf16 v[56:59], v[124:127], v[72:75], v[56:59]
    s_waitcnt lgkmcnt(0)
    v_mfma_f32_16x16x32_bf16 v[44:47], v[128:131], v[76:79], v[44:47]
    v_mfma_f32_16x16x32_bf16 v[48:51], v[132:135], v[76:79], v[48:51]
    v_mfma_f32_16x16x32_bf16 v[52:55], v[136:139], v[76:79], v[52:55]
    v_mfma_f32_16x16x32_bf16 v[56:59], v[140:143], v[76:79], v[56:59]
    s_mul_i32 s47, s37, 8320
    s_add_u32 s47, s47, 64
    s_mov_b32 s48, 0x05040100
    s_mov_b32 s49, 0x07060302
    s_cmp_eq_u32 s38, 0
    s_cbranch_scc0 L_B_kx1
    s_nop 0
    ds_write_b128 v5, v[52:55]
    ds_write_b128 v5, v[56:59] offset:1024
    s_waitcnt lgkmcnt(0)
    s_barrier
    ds_read_b128 v[56:59], v4
    ds_read_b128 v[60:63], v4 offset:1024
    s_waitcnt lgkmcnt(0)
    v_add_f32 v56, v56, v44
    v_add_f32 v57, v57, v45
    v_add_f32 v58, v58, v46
    v_add_f32 v59, v59, v47
    v_add_f32 v60, v60, v48
    v_add_f32 v61, v61, v49
    v_add_f32 v62, v62, v50
    v_add_f32 v63, v63, v51
    s_branch L_B_kxdone
L_B_kx1:
    ds_write_b128 v5, v[44:47]
    ds_write_b128 v5, v[48:51] offset:1024
    s_waitcnt lgkmcnt(0)
    s_barrier
    ds_read_b128 v[64:67], v4
    ds_read_b128 v[68:71], v4 offset:1024
    s_waitcnt lgkmcnt(0)
    v_add_f32 v63, v59, v71
    v_add_f32 v62, v58, v70
    v_add_f32 v61, v57, v69
    v_add_f32 v60, v56, v68
    v_add_f32 v59, v55, v67
    v_add_f32 v58, v54, v66
    v_add_f32 v57, v53, v65
    v_add_f32 v56, v52, v64
L_B_kxdone:
    buffer_load_dwordx2 v[22:23], v7, s[8:11], s44 offen offset:3072
    s_cmp_eq_u32 s32, 0
    s_cbranch_scc0 L_B_nonr
    s_bfe_u32 s54, s2, 0x20003
    s_lshl_b32 s54, s54, 6
    v_mov_b32 v30, s54
    global_load_dword v31, v30, s[64:65] sc1
L_B_nonr:
    s_cmp_eq_u32 s38, 0
    s_cbranch_scc0 L_B_half1
    v_lshrrev_b32 v4, 1, v3
    v_lshlrev_b32 v4, 8, v4
    v_lshl_add_u32 v4, v2, 4, v4
    v_and_b32 v5, 1, v3
    v_lshl_add_u32 v4, v5, 3, v4
    v_sub_u32 v4, 4088, v4
    v_add_u32 v4, s47, v4
    v_cvt_pk_bf16_f32 v64, v59, v58
    v_cvt_pk_bf16_f32 v65, v57, v56
    ds_write_b64 v4, v[64:65]
    v_and_b32 v5, 1, v2
    v_cmp_eq_u32 vcc, 1, v5
    v_lshlrev_b32 v4, 9, v3
    v_lshl_add_u32 v4, v2, 4, v4
    v_sub_u32 v4, 2032, v4
    v_add_u32 v4, s47, v4
    v_cndmask_b32 v6, v60, v61, vcc
    v_cndmask_b32 v7, v62, v63, vcc
    v_cvt_pk_bf16_f32 v68, v61, v61
    v_cvt_pk_bf16_f32 v69, v61, v6
    v_cvt_pk_bf16_f32 v70, v60, v60
    v_mov_b32 v71, v70
    v_add_u32 v5, -256, v4
    ds_write_b128 v4, v[68:71]
    v_cvt_pk_bf16_f32 v72, v63, v63
    v_cvt_pk_bf16_f32 v73, v63, v7
    v_cvt_pk_bf16_f32 v74, v62, v62
    v_mov_b32 v75, v74
    ds_write_b128 v5, v[72:75]
    s_branch L_B_exp1done
L_B_half1:
    v_lshlrev_b32 v4, 8, v3
    v_lshl_add_u32 v4, v2, 4, v4
    v_sub_u32 v5, 3056, v4
    v_add_u32 v5, s47, v5
    v_cvt_pk_bf16_f32 v64, v58, v58
    v_cvt_pk_bf16_f32 v65, v57, v57
    v_cvt_pk_bf16_f32 v66, v57, v56
    v_cvt_pk_bf16_f32 v67, v56, v56
    ds_write_b128 v5, v[64:67]
    v_sub_u32 v5, 3568, v4
    v_add_u32 v5, s47, v5
    v_cvt_pk_bf16_f32 v68, v59, v63
    v_cvt_pk_bf16_f32 v69, v62, v62
    v_cvt_pk_bf16_f32 v70, v62, v61
    v_cvt_pk_bf16_f32 v71, v60, v60
    v_mov_b32 v72, 0
    v_mov_b32 v73, 0
    v_mov_b32 v74, 0
    v_mov_b32 v75, 0
    v_lshlrev_b32 v6, 4, v1
    v_add_u32 v6, s47, v6
    s_mov_b32 exec_hi, 0
    ds_write_b128 v5, v[68:71]
    s_mov_b64 exec, 3
    ds_write_b128 v6, v[72:75] offset:4096
    s_mov_b64 exec, -1
L_B_exp1done:
    v_lshlrev_b32 v8, 3, v0
    v_add_u32 v8, 33856, v8
    s_cmp_lt_u32 s32, 2
    s_cbranch_scc0 L_B_nouz
    v_mov_b32 v76, 0
    v_mov_b32 v77, 0
    v_mov_b32 v78, 0
    v_mov_b32 v79, 0
    v_lshrrev_b32 v4, 5, v0
    v_mul_u32_u24 v4, 4608, v4
    v_and_b32 v5, 31, v0
    v_lshl_add_u32 v4, v5, 4, v4
    v_add_u32 v4, 33344, v4
    ds_write_b128 v4, v[76:79]
L_B_nouz:
    s_mul_i32 s50, s37, 4608
    s_lshl_b32 s51, s38, 6
    s_sub_u32 s50, s50, s51
    s_add_u32 s50, s50, 33440
    v_lshlrev_b32 v4, 5, v2
    v_lshl_add_u32 v4, v3, 4, v4
    v_add_u32 v9, s50, v4
    v_add_u32 v5, 1, v2
    v_and_b32 v6, 1, v5
    v_mul_u32_u24 v6, 4160, v6
    v_lshrrev_b32 v5, 1, v5
    v_lshlrev_b32 v5, 2, v5
    v_sub_u32 v6, v6, v5
    v_lshl_add_u32 v6, v3, 4, v6
    s_sub_u32 s50, s47, s51
    s_add_u32 s50, s50, 96
    v_add_u32 v10, s50, v6
    v_add_u32 v32, 1024, v10
    v_add_u32 v33, 2048, v10
    v_add_u32 v34, 3072, v10
    v_and_b32 v4, 127, v0
    v_lshlrev_b32 v4, 4, v4
    v_add_u32 v11, s47, v4
    v_add_u32 v12, -8, v11
    s_waitcnt lgkmcnt(0)
    s_barrier
    ds_read_b64 v[64:65], v12 offset:0
    ds_read_b128 v[66:69], v11 offset:0
    ds_read_b64 v[70:71], v12 offset:2048
    ds_read_b128 v[72:75], v11 offset:2048
    v_and_b32 v5, 127, v0
    v_cmp_gt_u32 vcc, 2, v5
    s_nop 0
    s_and_saveexec_b64 s[52:53], vcc
    s_cbranch_execz L_B_nost3r
    ds_read_b64 v[76:77], v12 offset:4096
    ds_read_b128 v[78:81], v11 offset:4096
L_B_nost3r:
    s_mov_b64 exec, s[52:53]
    s_waitcnt lgkmcnt(0)
    v_alignbit_b32 v84, v66, v65, 16
    v_alignbit_b32 v85, v67, v66, 16
    v_alignbit_b32 v86, v68, v67, 16
    v_alignbit_b32 v87, v69, v68, 16
    ds_write_b128 v11, v[84:87] offset:4160
    v_alignbit_b32 v96, v72, v71, 16
    v_alignbit_b32 v97, v73, v72, 16
    v_alignbit_b32 v98, v74, v73, 16
    v_alignbit_b32 v99, v75, v74, 16
    ds_write_b128 v11, v[96:99] offset:6208
    s_and_b64 exec, exec, vcc
    s_cbranch_execz L_B_nost3w
    v_alignbit_b32 v108, v78, v77, 16
    v_alignbit_b32 v109, v79, v78, 16
    v_alignbit_b32 v110, v80, v79, 16
    v_alignbit_b32 v111, v81, v80, 16
    ds_write_b128 v11, v[108:111] offset:8256
L_B_nost3w:
    s_mov_b64 exec, s[52:53]
    s_waitcnt vmcnt(0)
    v_perm_b32 v120, v18, v16, s48
    v_perm_b32 v121, v22, v20, s48
    ds_write_b64 v8, v[120:121] offset:0
    v_perm_b32 v122, v18, v16, s49
    v_perm_b32 v123, v22, v20, s49
    ds_write_b64 v8, v[122:123] offset:4608
    v_perm_b32 v124, v19, v17, s48
    v_perm_b32 v125, v23, v21, s48
    ds_write_b64 v8, v[124:125] offset:9216
    v_perm_b32 v126, v19, v17, s49
    v_perm_b32 v127, v23, v21, s49
    ds_write_b64 v8, v[126:127] offset:13824
    v_mov_b32 v224, 0
    v_mov_b32 v225, 0
    v_mov_b32 v226, 0
    v_mov_b32 v227, 0
    v_mov_b32 v228, 0
    v_mov_b32 v229, 0
    v_mov_b32 v230, 0
    v_mov_b32 v231, 0
    v_mov_b32 v232, 0
    v_mov_b32 v233, 0
    v_mov_b32 v234, 0
    v_mov_b32 v235, 0
    v_mov_b32 v236, 0
    v_mov_b32 v237, 0
    v_mov_b32 v238, 0
    v_mov_b32 v239, 0
    v_mov_b32 v240, 0
    v_mov_b32 v241, 0
    v_mov_b32 v242, 0
    v_mov_b32 v243, 0
    v_mov_b32 v244, 0
    v_mov_b32 v245, 0
    v_mov_b32 v246, 0
    v_mov_b32 v247, 0
    v_mov_b32 v248, 0
    v_mov_b32 v249, 0
    v_mov_b32 v250, 0
    v_mov_b32 v251, 0
    v_mov_b32 v252, 0
    v_mov_b32 v253, 0
    v_mov_b32 v254, 0
    v_mov_b32 v255, 0
    s_waitcnt lgkmcnt(0)
    s_barrier
    ds_read2_b32 v[76:77], v10 offset0:0 offset1:1
    ds_read2_b32 v[78:79], v10 offset0:2 offset1:3
    ds_read_b128 v[96:99], v9 offset:0
    ds_read2_b32 v[72:73], v10 offset0:32 offset1:33
    ds_read2_b32 v[74:75], v10 offset0:34 offset1:35
    ds_read_b128 v[100:103], v9 offset:128
    ds_read2_b32 v[68:69], v10 offset0:64 offset1:65
    ds_read2_b32 v[70:71], v10 offset0:66 offset1:67
    ds_read_b128 v[104:107], v9 offset:256
    s_waitcnt lgkmcnt(6)
    v_mfma_f32_16x16x32_bf16 v[252:255], v[76:79], v[96:99], v[252:255]
    ds_read2_b32 v[64:65], v10 offset0:96 offset1:97
    ds_read2_b32 v[66:67], v10 offset0:98 offset1:99
    ds_read_b128 v[108:111], v9 offset:384
    s_and_b32 s46, s2, 7
    s_lshr_b32 s51, s2, 3
    s_and_b32 s7, s51, 7
    s_lshr_b32 s51, s51, 3
    s_lshl_b32 s6, s46, 2
    s_add_u32 s6, s6, s51
    s_waitcnt lgkmcnt(6)
    v_mfma_f32_16x16x32_bf16 v[252:255], v[72:75], v[100:103], v[252:255]
    ds_read2_b32 v[76:77], v10 offset0:128 offset1:129
    ds_read2_b32 v[78:79], v10 offset0:130 offset1:131
    ds_read_b128 v[112:115], v9 offset:512
    s_and_b32 s3, s7, 1
    s_lshl_b32 s3, s3, 2
    s_lshl_b32 s4, s6, 6
    s_lshl_b32 s5, s7, 6
    v_lshrrev_b32 v26, 3, v1
    v_and_b32 v27, 7, v1
    s_waitcnt lgkmcnt(6)
    v_mfma_f32_16x16x32_bf16 v[252:255], v[68:71], v[104:107], v[252:255]
    ds_read2_b32 v[72:73], v10 offset0:160 offset1:161
    ds_read2_b32 v[74:75], v10 offset0:162 offset1:163
    ds_read_b128 v[116:119], v9 offset:640
    v_lshrrev_b32 v28, 1, v26
    v_xor_b32 v27, v27, v28
    v_xor_b32 v28, 4, v27
    v_lshlrev_b32 v26, 10, v26
    v_lshl_add_u32 v24, v27, 4, v26
    v_lshl_add_u32 v25, v28, 4, v26
    s_waitcnt lgkmcnt(6)
    v_mfma_f32_16x16x32_bf16 v[252:255], v[64:67], v[108:111], v[252:255]
    ds_read2_b32 v[68:69], v10 offset0:192 offset1:193
    ds_read2_b32 v[70:71], v10 offset0:194 offset1:195
    ds_read_b128 v[120:123], v9 offset:768
    v_add_u32 v25, 0x2000, v25
    s_and_b32 s46, s32, 3
    s_lshl_b32 s46, s46, 4
    s_add_u32 s46, s46, s5
    s_lshl_b32 s46, s46, 10
    v_add_u32 v24, s46, v24
    s_waitcnt lgkmcnt(6)
    v_mfma_f32_16x16x32_bf16 v[252:255], v[76:79], v[112:115], v[252:255]
    ds_read2_b32 v[64:65], v10 offset0:224 offset1:225
    v_mfma_f32_16x16x32_bf16 v[248:251], v[76:79], v[96:99], v[248:251]
    ds_read2_b32 v[66:67], v10 offset0:226 offset1:227
    ds_read_b128 v[124:127], v9 offset:896
    v_add_u32 v25, s46, v25
    s_waitcnt lgkmcnt(6)
    v_mfma_f32_16x16x32_bf16 v[252:255], v[72:75], v[116:119], v[252:255]
    ds_read2_b32 v[76:77], v32 offset0:0 offset1:1
    v_mfma_f32_16x16x32_bf16 v[248:251], v[72:75], v[100:103], v[248:251]
    ds_read2_b32 v[78:79], v32 offset0:2 offset1:3
    ds_read_b128 v[128:131], v9 offset:1024
    s_cmp_lt_u32 s32, 4
    s_cselect_b32 s12, s28, s30
    s_cselect_b32 s13, s29, s31
    s_mov_b32 s14, 0x80000
    s_mov_b32 s15, 0x20000
    s_waitcnt lgkmcnt(6)
    v_mfma_f32_16x16x32_bf16 v[252:255], v[68:71], v[120:123], v[252:255]
    ds_read2_b32 v[72:73], v32 offset0:32 offset1:33
    v_mfma_f32_16x16x32_bf16 v[248:251], v[68:71], v[104:107], v[248:251]
    ds_read2_b32 v[74:75], v32 offset0:34 offset1:35
    ds_read_b128 v[132:135], v9 offset:1152
    s_add_u32 s51, s3, 4
    s_and_b32 s51, s51, 7
    s_lshl_b32 s51, s51, 7
    s_lshl_b32 s54, s32, 11
    s_add_u32 m0, s54, 65536
    s_nop 0
    buffer_load_dwordx4 v24, s[12:15], s51 offen lds
    s_add_u32 m0, s54, 66560
    s_nop 0
    buffer_load_dwordx4 v25, s[12:15], s51 offen lds
    s_waitcnt lgkmcnt(6)
    v_mfma_f32_16x16x32_bf16 v[252:255], v[64:67], v[124:127], v[252:255]
    ds_read2_b32 v[68:69], v32 offset0:64 offset1:65
    v_mfma_f32_16x16x32_bf16 v[248:251], v[64:67], v[108:111], v[248:251]
    ds_read2_b32 v[70:71], v32 offset0:66 offset1:67
    ds_read_b128 v[136:139], v9 offset:1280
    s_add_u32 s51, s3, 5
    s_and_b32 s51, s51, 7
    s_lshl_b32 s51, s51, 7
    s_lshl_b32 s54, s32, 11
    s_add_u32 m0, s54, 81920
    s_nop 0
    buffer_load_dwordx4 v24, s[12:15], s51 offen lds
    s_add_u32 m0, s54, 82944
    s_nop 0
    buffer_load_dwordx4 v25, s[12:15], s51 offen lds
    s_waitcnt lgkmcnt(6)
    v_mfma_f32_16x16x32_bf16 v[252:255], v[76:79], v[128:131], v[252:255]
    ds_read2_b32 v[64:65], v32 offset0:96 offset1:97
    v_mfma_f32_16x16x32_bf16 v[248:251], v[76:79], v[112:115], v[248:251]
    ds_read2_b32 v[66:67], v32 offset0:98 offset1:99
    v_mfma_f32_16x16x32_bf16 v[244:247], v[76:79], v[96:99], v[244:247]
    ds_read_b128 v[140:143], v9 offset:1408
    s_add_u32 s51, s3, 6
    s_and_b32 s51, s51, 7
    s_lshl_b32 s51, s51, 7
    s_lshl_b32 s54, s32, 11
    s_add_u32 m0, s54, 98304
    s_nop 0
    buffer_load_dwordx4 v24, s[12:15], s51 offen lds
    s_add_u32 m0, s54, 99328
    s_nop 0
    buffer_load_dwordx4 v25, s[12:15], s51 offen lds
    s_waitcnt lgkmcnt(6)
    v_mfma_f32_16x16x32_bf16 v[252:255], v[72:75], v[132:135], v[252:255]
    ds_read2_b32 v[76:77], v32 offset0:128 offset1:129
    v_mfma_f32_16x16x32_bf16 v[248:251], v[72:75], v[116:119], v[248:251]
    ds_read2_b32 v[78:79], v32 offset0:130 offset1:131
    v_mfma_f32_16x16x32_bf16 v[244:247], v[72:75], v[100:103], v[244:247]
    ds_read_b128 v[144:147], v9 offset:1536
    s_add_u32 s51, s3, 7
    s_and_b32 s51, s51, 7
    s_lshl_b32 s51, s51, 7
    s_lshl_b32 s54, s32, 11
    s_add_u32 m0, s54, 114688
    s_nop 0
    buffer_load_dwordx4 v24, s[12:15], s51 offen lds
    s_add_u32 m0, s54, 115712
    s_nop 0
    buffer_load_dwordx4 v25, s[12:15], s51 offen lds
    s_waitcnt lgkmcnt(6)
    v_mfma_f32_16x16x32_bf16 v[252:255], v[68:71], v[136:139], v[252:255]
    ds_read2_b32 v[72:73], v32 offset0:160 offset1:161
    v_mfma_f32_16x16x32_bf16 v[248:251], v[68:71], v[120:123], v[248:251]
    ds_read2_b32 v[74:75], v32 offset0:162 offset1:163
    v_mfma_f32_16x16x32_bf16 v[244:247], v[68:71], v[104:107], v[244:247]
    ds_read_b128 v[148:151], v9 offset:1664
    s_waitcnt lgkmcnt(6)
    v_mfma_f32_16x16x32_bf16 v[252:255], v[64:67], v[140:143], v[252:255]
    ds_read2_b32 v[68:69], v32 offset0:192 offset1:193
    v_mfma_f32_16x16x32_bf16 v[248:251], v[64:67], v[124:127], v[248:251]
    ds_read2_b32 v[70:71], v32 offset0:194 offset1:195
    v_mfma_f32_16x16x32_bf16 v[244:247], v[64:67], v[108:111], v[244:247]
    ds_read_b128 v[152:155], v9 offset:1792
    s_waitcnt lgkmcnt(6)
    v_mfma_f32_16x16x32_bf16 v[252:255], v[76:79], v[144:147], v[252:255]
    ds_read2_b32 v[64:65], v32 offset0:224 offset1:225
    v_mfma_f32_16x16x32_bf16 v[248:251], v[76:79], v[128:131], v[248:251]
    ds_read2_b32 v[66:67], v32 offset0:226 offset1:227
    v_mfma_f32_16x16x32_bf16 v[244:247], v[76:79], v[112:115], v[244:247]
    ds_read_b128 v[156:159], v9 offset:1920
    v_mfma_f32_16x16x32_bf16 v[240:243], v[76:79], v[96:99], v[240:243]
    s_waitcnt lgkmcnt(6)
    v_mfma_f32_16x16x32_bf16 v[252:255], v[72:75], v[148:151], v[252:255]
    ds_read2_b32 v[76:77], v33 offset0:0 offset1:1
    v_mfma_f32_16x16x32_bf16 v[248:251], v[72:75], v[132:135], v[248:251]
    ds_read2_b32 v[78:79], v33 offset0:2 offset1:3
    v_mfma_f32_16x16x32_bf16 v[244:247], v[72:75], v[116:119], v[244:247]
    ds_read_b128 v[160:163], v9 offset:2048
    v_mfma_f32_16x16x32_bf16 v[240:243], v[72:75], v[100:103], v[240:243]
    s_waitcnt lgkmcnt(6)
    v_mfma_f32_16x16x32_bf16 v[252:255], v[68:71], v[152:155], v[252:255]
    ds_read2_b32 v[72:73], v33 offset0:32 offset1:33
    v_mfma_f32_16x16x32_bf16 v[248:251], v[68:71], v[136:139], v[248:251]
    ds_read2_b32 v[74:75], v33 offset0:34 offset1:35
    v_mfma_f32_16x16x32_bf16 v[244:247], v[68:71], v[120:123], v[244:247]
    ds_read_b128 v[164:167], v9 offset:2176
    v_mfma_f32_16x16x32_bf16 v[240:243], v[68:71], v[104:107], v[240:243]
    s_waitcnt lgkmcnt(6)
    v_mfma_f32_16x16x32_bf16 v[252:255], v[64:67], v[156:159], v[252:255]
    ds_read2_b32 v[68:69], v33 offset0:64 offset1:65
    v_mfma_f32_16x16x32_bf16 v[248:251], v[64:67], v[140:143], v[248:251]
    ds_read2_b32 v[70:71], v33 offset0:66 offset1:67
    v_mfma_f32_16x16x32_bf16 v[244:247], v[64:67], v[124:127], v[244:247]
    ds_read_b128 v[168:171], v9 offset:2304
    v_mfma_f32_16x16x32_bf16 v[240:243], v[64:67], v[108:111], v[240:243]
    s_waitcnt lgkmcnt(6)
    v_mfma_f32_16x16x32_bf16 v[252:255], v[76:79], v[160:163], v[252:255]
    ds_read2_b32 v[64:65], v33 offset0:96 offset1:97
    v_mfma_f32_16x16x32_bf16 v[248:251], v[76:79], v[144:147], v[248:251]
    ds_read2_b32 v[66:67], v33 offset0:98 offset1:99
    v_mfma_f32_16x16x32_bf16 v[244:247], v[76:79], v[128:131], v[244:247]
    ds_read_b128 v[172:175], v9 offset:2432
    v_mfma_f32_16x16x32_bf16 v[240:243], v[76:79], v[112:115], v[240:243]
    v_mfma_f32_16x16x32_bf16 v[236:239], v[76:79], v[96:99], v[236:239]
    s_waitcnt lgkmcnt(6)
    v_mfma_f32_16x16x32_bf16 v[252:255], v[72:75], v[164:167], v[252:255]
    ds_read2_b32 v[76:77], v33 offset0:128 offset1:129
    v_mfma_f32_16x16x32_bf16 v[248:251], v[72:75], v[148:151], v[248:251]
    ds_read2_b32 v[78:79], v33 offset0:130 offset1:131
    v_mfma_f32_16x16x32_bf16 v[244:247], v[72:75], v[132:135], v[244:247]
    ds_read_b128 v[176:179], v9 offset:2560
    v_mfma_f32_16x16x32_bf16 v[240:243], v[72:75], v[116:119], v[240:243]
    v_mfma_f32_16x16x32_bf16 v[236:239], v[72:75], v[100:103], v[236:239]
    s_waitcnt lgkmcnt(6)
    v_mfma_f32_16x16x32_bf16 v[252:255], v[68:71], v[168:171], v[252:255]
    ds_read2_b32 v[72:73], v33 offset0:160 offset1:161
    v_mfma_f32_16x16x32_bf16 v[248:251], v[68:71], v[152:155], v[248:251]
    ds_read2_b32 v[74:75], v33 offset0:162 offset1:163
    v_mfma_f32_16x16x32_bf16 v[244:247], v[68:71], v[136:139], v[244:247]
    ds_read_b128 v[180:183], v9 offset:2688
    v_mfma_f32_16x16x32_bf16 v[240:243], v[68:71], v[120:123], v[240:243]
    v_mfma_f32_16x16x32_bf16 v[236:239], v[68:71], v[104:107], v[236:239]
    s_waitcnt lgkmcnt(6)
    v_mfma_f32_16x16x32_bf16 v[252:255], v[64:67], v[172:175], v[252:255]
    ds_read2_b32 v[68:69], v33 offset0:192 offset1:193
    v_mfma_f32_16x16x32_bf16 v[248:251], v[64:67], v[156:159], v[248:251]
    ds_read2_b32 v[70:71], v33 offset0:194 offset1:195
    v_mfma_f32_16x16x32_bf16 v[244:247], v[64:67], v[140:143], v[244:247]
    ds_read_b128 v[184:187], v9 offset:2816
    v_mfma_f32_16x16x32_bf16 v[240:243], v[64:67], v[124:127], v[240:243]
    v_mfma_f32_16x16x32_bf16 v[236:239], v[64:67], v[108:111], v[236:239]
    s_waitcnt lgkmcnt(6)
    v_mfma_f32_16x16x32_bf16 v[252:255], v[76:79], v[176:179], v[252:255]
    ds_read2_b32 v[64:65], v33 offset0:224 offset1:225
    v_mfma_f32_16x16x32_bf16 v[248:251], v[76:79], v[160:163], v[248:251]
    v_mfma_f32_16x16x32_bf16 v[244:247], v[76:79], v[144:147], v[244:247]
    ds_read2_b32 v[66:67], v33 offset0:226 offset1:227
    v_mfma_f32_16x16x32_bf16 v[240:243], v[76:79], v[128:131], v[240:243]
    v_mfma_f32_16x16x32_bf16 v[236:239], v[76:79], v[112:115], v[236:239]
    ds_read_b128 v[188:191], v9 offset:2944
    v_mfma_f32_16x16x32_bf16 v[232:235], v[76:79], v[96:99], v[232:235]
    s_waitcnt lgkmcnt(6)
    v_mfma_f32_16x16x32_bf16 v[252:255], v[72:75], v[180:183], v[252:255]
    ds_read2_b32 v[76:77], v34 offset0:0 offset1:1
    v_mfma_f32_16x16x32_bf16 v[248:251], v[72:75], v[164:167], v[248:251]
    v_mfma_f32_16x16x32_bf16 v[244:247], v[72:75], v[148:151], v[244:247]
    ds_read2_b32 v[78:79], v34 offset0:2 offset1:3
    v_mfma_f32_16x16x32_bf16 v[240:243], v[72:75], v[132:135], v[240:243]
    v_mfma_f32_16x16x32_bf16 v[236:239], v[72:75], v[116:119], v[236:239]
    ds_read_b128 v[192:195], v9 offset:3072
    v_mfma_f32_16x16x32_bf16 v[232:235], v[72:75], v[100:103], v[232:235]
    s_waitcnt lgkmcnt(6)
    v_mfma_f32_16x16x32_bf16 v[252:255], v[68:71], v[184:187], v[252:255]
    ds_read2_b32 v[72:73], v34 offset0:32 offset1:33
    v_mfma_f32_16x16x32_bf16 v[248:251], v[68:71], v[168:171], v[248:251]
    v_mfma_f32_16x16x32_bf16 v[244:247], v[68:71], v[152:155], v[244:247]
    ds_read2_b32 v[74:75], v34 offset0:34 offset1:35
    v_mfma_f32_16x16x32_bf16 v[240:243], v[68:71], v[136:139], v[240:243]
    v_mfma_f32_16x16x32_bf16 v[236:239], v[68:71], v[120:123], v[236:239]
    ds_read_b128 v[196:199], v9 offset:3200
    v_mfma_f32_16x16x32_bf16 v[232:235], v[68:71], v[104:107], v[232:235]
    s_waitcnt lgkmcnt(6)
    v_mfma_f32_16x16x32_bf16 v[252:255], v[64:67], v[188:191], v[252:255]
    ds_read2_b32 v[68:69], v34 offset0:64 offset1:65
    v_mfma_f32_16x16x32_bf16 v[248:251], v[64:67], v[172:175], v[248:251]
    v_mfma_f32_16x16x32_bf16 v[244:247], v[64:67], v[156:159], v[244:247]
    ds_read2_b32 v[70:71], v34 offset0:66 offset1:67
    v_mfma_f32_16x16x32_bf16 v[240:243], v[64:67], v[140:143], v[240:243]
    v_mfma_f32_16x16x32_bf16 v[236:239], v[64:67], v[124:127], v[236:239]
    ds_read_b128 v[200:203], v9 offset:3328
    v_mfma_f32_16x16x32_bf16 v[232:235], v[64:67], v[108:111], v[232:235]
    s_waitcnt lgkmcnt(6)
    v_mfma_f32_16x16x32_bf16 v[252:255], v[76:79], v[192:195], v[252:255]
    ds_read2_b32 v[64:65], v34 offset0:96 offset1:97
    v_mfma_f32_16x16x32_bf16 v[248:251], v[76:79], v[176:179], v[248:251]
    v_mfma_f32_16x16x32_bf16 v[244:247], v[76:79], v[160:163], v[244:247]
    ds_read2_b32 v[66:67], v34 offset0:98 offset1:99
    v_mfma_f32_16x16x32_bf16 v[240:243], v[76:79], v[144:147], v[240:243]
    v_mfma_f32_16x16x32_bf16 v[236:239], v[76:79], v[128:131], v[236:239]
    ds_read_b128 v[204:207], v9 offset:3456
    v_mfma_f32_16x16x32_bf16 v[232:235], v[76:79], v[112:115], v[232:235]
    v_mfma_f32_16x16x32_bf16 v[228:231], v[76:79], v[96:99], v[228:231]
    s_waitcnt lgkmcnt(6)
    v_mfma_f32_16x16x32_bf16 v[252:255], v[72:75], v[196:199], v[252:255]
    ds_read2_b32 v[76:77], v34 offset0:128 offset1:129
    v_mfma_f32_16x16x32_bf16 v[248:251], v[72:75], v[180:183], v[248:251]
    v_mfma_f32_16x16x32_bf16 v[244:247], v[72:75], v[164:167], v[244:247]
    ds_read2_b32 v[78:79], v34 offset0:130 offset1:131
    v_mfma_f32_16x16x32_bf16 v[240:243], v[72:75], v[148:151], v[240:243]
    v_mfma_f32_16x16x32_bf16 v[236:239], v[72:75], v[132:135], v[236:239]
    ds_read_b128 v[208:211], v9 offset:3584
    v_mfma_f32_16x16x32_bf16 v[232:235], v[72:75], v[116:119], v[232:235]
    v_mfma_f32_16x16x32_bf16 v[228:231], v[72:75], v[100:103], v[228:231]
    s_waitcnt lgkmcnt(6)
    v_mfma_f32_16x16x32_bf16 v[252:255], v[68:71], v[200:203], v[252:255]
    ds_read2_b32 v[72:73], v34 offset0:160 offset1:161
    v_mfma_f32_16x16x32_bf16 v[248:251], v[68:71], v[184:187], v[248:251]
    v_mfma_f32_16x16x32_bf16 v[244:247], v[68:71], v[168:171], v[244:247]
    ds_read2_b32 v[74:75], v34 offset0:162 offset1:163
    v_mfma_f32_16x16x32_bf16 v[240:243], v[68:71], v[152:155], v[240:243]
    v_mfma_f32_16x16x32_bf16 v[236:239], v[68:71], v[136:139], v[236:239]
    ds_read_b128 v[212:215], v9 offset:3712
    v_mfma_f32_16x16x32_bf16 v[232:235], v[68:71], v[120:123], v[232:235]
    v_mfma_f32_16x16x32_bf16 v[228:231], v[68:71], v[104:107], v[228:231]
    s_waitcnt lgkmcnt(6)
    v_mfma_f32_16x16x32_bf16 v[252:255], v[64:67], v[204:207], v[252:255]
    ds_read2_b32 v[68:69], v34 offset0:192 offset1:193
    v_mfma_f32_16x16x32_bf16 v[248:251], v[64:67], v[188:191], v[248:251]
    v_mfma_f32_16x16x32_bf16 v[244:247], v[64:67], v[172:175], v[244:247]
    ds_read2_b32 v[70:71], v34 offset0:194 offset1:195
    v_mfma_f32_16x16x32_bf16 v[240:243], v[64:67], v[156:159], v[240:243]
    v_mfma_f32_16x16x32_bf16 v[236:239], v[64:67], v[140:143], v[236:239]
    ds_read_b128 v[216:219], v9 offset:3840
    v_mfma_f32_16x16x32_bf16 v[232:235], v[64:67], v[124:127], v[232:235]
    v_mfma_f32_16x16x32_bf16 v[228:231], v[64:67], v[108:111], v[228:231]
    s_waitcnt lgkmcnt(6)
    v_mfma_f32_16x16x32_bf16 v[252:255], v[76:79], v[208:211], v[252:255]
    ds_read2_b32 v[64:65], v34 offset0:224 offset1:225
    v_mfma_f32_16x16x32_bf16 v[248:251], v[76:79], v[192:195], v[248:251]
    v_mfma_f32_16x16x32_bf16 v[244:247], v[76:79], v[176:179], v[244:247]
    ds_read2_b32 v[66:67], v34 offset0:226 offset1:227
    v_mfma_f32_16x16x32_bf16 v[240:243], v[76:79], v[160:163], v[240:243]
    v_mfma_f32_16x16x32_bf16 v[236:239], v[76:79], v[144:147], v[236:239]
    ds_read_b128 v[220:223], v9 offset:3968
    v_mfma_f32_16x16x32_bf16 v[232:235], v[76:79], v[128:131], v[232:235]
    v_mfma_f32_16x16x32_bf16 v[228:231], v[76:79], v[112:115], v[228:231]
    v_mfma_f32_16x16x32_bf16 v[224:227], v[76:79], v[96:99], v[224:227]
    s_waitcnt lgkmcnt(6)
    v_mfma_f32_16x16x32_bf16 v[252:255], v[72:75], v[212:215], v[252:255]
    v_mfma_f32_16x16x32_bf16 v[248:251], v[72:75], v[196:199], v[248:251]
    v_mfma_f32_16x16x32_bf16 v[244:247], v[72:75], v[180:183], v[244:247]
    v_mfma_f32_16x16x32_bf16 v[240:243], v[72:75], v[164:167], v[240:243]
    v_mfma_f32_16x16x32_bf16 v[236:239], v[72:75], v[148:151], v[236:239]
    v_mfma_f32_16x16x32_bf16 v[232:235], v[72:75], v[132:135], v[232:235]
    v_mfma_f32_16x16x32_bf16 v[228:231], v[72:75], v[116:119], v[228:231]
    v_mfma_f32_16x16x32_bf16 v[224:227], v[72:75], v[100:103], v[224:227]
    s_waitcnt lgkmcnt(3)
    v_mfma_f32_16x16x32_bf16 v[252:255], v[68:71], v[216:219], v[252:255]
    v_mfma_f32_16x16x32_bf16 v[248:251], v[68:71], v[200:203], v[248:251]
    v_mfma_f32_16x16x32_bf16 v[244:247], v[68:71], v[184:187], v[244:247]
    v_mfma_f32_16x16x32_bf16 v[240:243], v[68:71], v[168:171], v[240:243]
    v_mfma_f32_16x16x32_bf16 v[236:239], v[68:71], v[152:155], v[236:239]
    v_mfma_f32_16x16x32_bf16 v[232:235], v[68:71], v[136:139], v[232:235]
    v_mfma_f32_16x16x32_bf16 v[228:231], v[68:71], v[120:123], v[228:231]
    v_mfma_f32_16x16x32_bf16 v[224:227], v[68:71], v[104:107], v[224:227]
    s_waitcnt lgkmcnt(0)
    v_mfma_f32_16x16x32_bf16 v[252:255], v[64:67], v[220:223], v[252:255]
    v_mfma_f32_16x16x32_bf16 v[248:251], v[64:67], v[204:207], v[248:251]
    v_mfma_f32_16x16x32_bf16 v[244:247], v[64:67], v[188:191], v[244:247]
    v_mfma_f32_16x16x32_bf16 v[240:243], v[64:67], v[172:175], v[240:243]
    v_mfma_f32_16x16x32_bf16 v[236:239], v[64:67], v[156:159], v[236:239]
    v_mfma_f32_16x16x32_bf16 v[232:235], v[64:67], v[140:143], v[232:235]
    v_mfma_f32_16x16x32_bf16 v[228:231], v[64:67], v[124:127], v[228:231]
    v_mfma_f32_16x16x32_bf16 v[224:227], v[64:67], v[108:111], v[224:227]
    s_mul_i32 s50, s37, 4608
    s_lshl_b32 s51, s38, 11
    s_add_u32 s50, s50, s51
    s_add_u32 s50, s50, 33856
    v_lshlrev_b32 v6, 5, v2
    v_lshl_add_u32 v6, v3, 3, v6
    v_add_u32 v7, s50, v6
    ds_read_b64 v[64:65], v7 offset:0
    ds_read_b64 v[66:67], v7 offset:512
    ds_read_b64 v[68:69], v7 offset:1024
    ds_read_b64 v[70:71], v7 offset:1536
    s_lshl_b32 s50, s32, 12
    s_add_u32 s50, s50, 131072
    v_lshlrev_b32 v4, 4, v1
    v_add_u32 v5, s50, v4
    s_xor_b32 s50, s32, 1
    s_lshl_b32 s50, s50, 12
    s_add_u32 s50, s50, 131072
    v_add_u32 v4, s50, v4
    v_and_b32 v8, 1, v3
    v_lshlrev_b32 v8, 9, v8
    v_lshl_add_u32 v8, v2, 5, v8
    v_lshrrev_b32 v9, 1, v3
    v_lshl_add_u32 v8, v9, 4, v8
    s_lshl_b32 s50, s39, 12
    s_add_u32 s50, s50, s51
    s_add_u32 s50, s50, 0x400000
    s_cmp_eq_u32 s38, 1
    s_cbranch_scc1 L_B_par1
    ds_write_b128 v5, v[240:243] offset:0
    ds_write_b128 v5, v[244:247] offset:1024
    ds_write_b128 v5, v[248:251] offset:2048
    ds_write_b128 v5, v[252:255] offset:3072
    s_waitcnt lgkmcnt(4)
    v_lshlrev_b32 v72, 16, v64
    v_and_b32 v73, 0xffff0000, v64
    v_lshlrev_b32 v74, 16, v65
    v_and_b32 v75, 0xffff0000, v65
    v_lshlrev_b32 v76, 16, v66
    v_and_b32 v77, 0xffff0000, v66
    v_lshlrev_b32 v78, 16, v67
    v_and_b32 v79, 0xffff0000, v67
    v_lshlrev_b32 v80, 16, v68
    v_and_b32 v81, 0xffff0000, v68
    v_lshlrev_b32 v82, 16, v69
    v_and_b32 v83, 0xffff0000, v69
    v_lshlrev_b32 v84, 16, v70
    v_and_b32 v85, 0xffff0000, v70
    v_lshlrev_b32 v86, 16, v71
    v_and_b32 v87, 0xffff0000, v71
    v_fmac_f32 v224, v72, v13
    v_fmac_f32 v225, v73, v13
    v_fmac_f32 v226, v74, v13
    v_fmac_f32 v227, v75, v13
    v_fmac_f32 v228, v76, v13
    v_fmac_f32 v229, v77, v13
    v_fmac_f32 v230, v78, v13
    v_fmac_f32 v231, v79, v13
    v_fmac_f32 v232, v80, v13
    v_fmac_f32 v233, v81, v13
    v_fmac_f32 v234, v82, v13
    v_fmac_f32 v235, v83, v13
    v_fmac_f32 v236, v84, v13
    v_fmac_f32 v237, v85, v13
    v_fmac_f32 v238, v86, v13
    v_fmac_f32 v239, v87, v13
    s_load_dwordx2 s[8:9], s[0:1], 0
    s_load_dwordx2 s[20:21], s[0:1], 136
    s_load_dwordx2 s[24:25], s[0:1], 64
    s_waitcnt lgkmcnt(0)
    s_barrier
    ds_read_b128 v[96:99], v4 offset:0
    ds_read_b128 v[100:103], v4 offset:1024
    ds_read_b128 v[104:107], v4 offset:2048
    ds_read_b128 v[108:111], v4 offset:3072
    s_waitcnt lgkmcnt(3)
    v_add_f32 v224, v224, v96
    v_add_f32 v225, v225, v97
    v_add_f32 v226, v226, v98
    v_add_f32 v227, v227, v99
    v_cvt_pk_bf16_f32 v112, v224, v225
    v_cvt_pk_bf16_f32 v113, v226, v227
    s_waitcnt lgkmcnt(2)
    v_add_f32 v228, v228, v100
    v_add_f32 v229, v229, v101
    v_add_f32 v230, v230, v102
    v_add_f32 v231, v231, v103
    v_cvt_pk_bf16_f32 v114, v228, v229
    v_cvt_pk_bf16_f32 v115, v230, v231
    s_waitcnt lgkmcnt(1)
    v_add_f32 v232, v232, v104
    v_add_f32 v233, v233, v105
    v_add_f32 v234, v234, v106
    v_add_f32 v235, v235, v107
    v_cvt_pk_bf16_f32 v116, v232, v233
    v_cvt_pk_bf16_f32 v117, v234, v235
    s_waitcnt lgkmcnt(0)
    v_add_f32 v236, v236, v108
    v_add_f32 v237, v237, v109
    v_add_f32 v238, v238, v110
    v_add_f32 v239, v239, v111
    v_cvt_pk_bf16_f32 v118, v236, v237
    v_cvt_pk_bf16_f32 v119, v238, v239
    v_permlane16_swap_b32 v112, v114
    v_permlane16_swap_b32 v113, v115
    buffer_store_dwordx4 v[112:115], v8, s[16:19], s50 offen offset:0 sc1
    v_permlane16_swap_b32 v116, v118
    v_permlane16_swap_b32 v117, v119
    buffer_store_dwordx4 v[116:119], v8, s[16:19], s50 offen offset:1024 sc1
    s_branch L_B_fin
L_B_par1:
    ds_write_b128 v5, v[224:227] offset:0
    ds_write_b128 v5, v[228:231] offset:1024
    ds_write_b128 v5, v[232:235] offset:2048
    ds_write_b128 v5, v[236:239] offset:3072
    s_waitcnt lgkmcnt(4)
    v_lshlrev_b32 v72, 16, v64
    v_and_b32 v73, 0xffff0000, v64
    v_lshlrev_b32 v74, 16, v65
    v_and_b32 v75, 0xffff0000, v65
    v_lshlrev_b32 v76, 16, v66
    v_and_b32 v77, 0xffff0000, v66
    v_lshlrev_b32 v78, 16, v67
    v_and_b32 v79, 0xffff0000, v67
    v_lshlrev_b32 v80, 16, v68
    v_and_b32 v81, 0xffff0000, v68
    v_lshlrev_b32 v82, 16, v69
    v_and_b32 v83, 0xffff0000, v69
    v_lshlrev_b32 v84, 16, v70
    v_and_b32 v85, 0xffff0000, v70
    v_lshlrev_b32 v86, 16, v71
    v_and_b32 v87, 0xffff0000, v71
    v_fmac_f32 v240, v72, v13
    v_fmac_f32 v241, v73, v13
    v_fmac_f32 v242, v74, v13
    v_fmac_f32 v243, v75, v13
    v_fmac_f32 v244, v76, v13
    v_fmac_f32 v245, v77, v13
    v_fmac_f32 v246, v78, v13
    v_fmac_f32 v247, v79, v13
    v_fmac_f32 v248, v80, v13
    v_fmac_f32 v249, v81, v13
    v_fmac_f32 v250, v82, v13
    v_fmac_f32 v251, v83, v13
    v_fmac_f32 v252, v84, v13
    v_fmac_f32 v253, v85, v13
    v_fmac_f32 v254, v86, v13
    v_fmac_f32 v255, v87, v13
    s_load_dwordx2 s[8:9], s[0:1], 0
    s_load_dwordx2 s[20:21], s[0:1], 136
    s_load_dwordx2 s[24:25], s[0:1], 64
    s_waitcnt lgkmcnt(0)
    s_barrier
    ds_read_b128 v[96:99], v4 offset:0
    ds_read_b128 v[100:103], v4 offset:1024
    ds_read_b128 v[104:107], v4 offset:2048
    ds_read_b128 v[108:111], v4 offset:3072
    s_waitcnt lgkmcnt(3)
    v_add_f32 v240, v240, v96
    v_add_f32 v241, v241, v97
    v_add_f32 v242, v242, v98
    v_add_f32 v243, v243, v99
    v_cvt_pk_bf16_f32 v112, v240, v241
    v_cvt_pk_bf16_f32 v113, v242, v243
    s_waitcnt lgkmcnt(2)
    v_add_f32 v244, v244, v100
    v_add_f32 v245, v245, v101
    v_add_f32 v246, v246, v102
    v_add_f32 v247, v247, v103
    v_cvt_pk_bf16_f32 v114, v244, v245
    v_cvt_pk_bf16_f32 v115, v246, v247
    s_waitcnt lgkmcnt(1)
    v_add_f32 v248, v248, v104
    v_add_f32 v249, v249, v105
    v_add_f32 v250, v250, v106
    v_add_f32 v251, v251, v107
    v_cvt_pk_bf16_f32 v116, v248, v249
    v_cvt_pk_bf16_f32 v117, v250, v251
    s_waitcnt lgkmcnt(0)
    v_add_f32 v252, v252, v108
    v_add_f32 v253, v253, v109
    v_add_f32 v254, v254, v110
    v_add_f32 v255, v255, v111
    v_cvt_pk_bf16_f32 v118, v252, v253
    v_cvt_pk_bf16_f32 v119, v254, v255
    v_permlane16_swap_b32 v112, v114
    v_permlane16_swap_b32 v113, v115
    buffer_store_dwordx4 v[112:115], v8, s[16:19], s50 offen offset:0 sc1
    v_permlane16_swap_b32 v116, v118
    v_permlane16_swap_b32 v117, v119
    buffer_store_dwordx4 v[116:119], v8, s[16:19], s50 offen offset:1024 sc1
L_B_fin:
    s_lshl_b32 s69, s33, 6
    s_lshl_b32 s68, s34, 2
    s_add_u32 s69, s69, s68
    s_add_u32 s69, s69, 0x622400
    s_cmp_eq_u32 s32, 0
    s_cbranch_scc0 L_B_nonc
    s_mov_b32 s55, 0x8000
L_B_nonp:
    v_readfirstlane_b32 s70, v31
    s_nop 0
    s_cmp_lg_u32 s70, 0
    s_cbranch_scc1 L_B_nonc
    global_load_dword v31, v30, s[64:65] sc1
    s_waitcnt vmcnt(0)
    s_sub_u32 s55, s55, 1
    s_cmp_lg_u32 s55, 0
    s_cbranch_scc1 L_B_nonp
L_B_nonc:
    s_waitcnt lgkmcnt(0)
    s_barrier
    s_add_u32 s51, s3, 0
    s_and_b32 s51, s51, 7
    s_lshl_b32 s51, s51, 7
    s_lshl_b32 s54, s32, 11
    s_add_u32 m0, s54, 0
    s_nop 0
    buffer_load_dwordx4 v24, s[12:15], s51 offen lds
    s_add_u32 m0, s54, 1024
    s_nop 0
    buffer_load_dwordx4 v25, s[12:15], s51 offen lds
    s_add_u32 s51, s3, 1
    s_and_b32 s51, s51, 7
    s_lshl_b32 s51, s51, 7
    s_lshl_b32 s54, s32, 11
    s_add_u32 m0, s54, 16384
    s_nop 0
    buffer_load_dwordx4 v24, s[12:15], s51 offen lds
    s_add_u32 m0, s54, 17408
    s_nop 0
    buffer_load_dwordx4 v25, s[12:15], s51 offen lds
    s_waitcnt vmcnt(4)
    s_barrier
    s_cmp_eq_u32 s32, 0
    s_cbranch_scc0 L_T_nopub1195
    v_mov_b32 v32, s70
    v_mov_b32 v33, s69
    s_mov_b64 exec, 1
    buffer_store_dword v32, v33, s[16:19], 0 offen sc1
    s_mov_b64 exec, -1
L_T_nopub1195:
    s_add_u32 s51, s3, 2
    s_and_b32 s51, s51, 7
    s_lshl_b32 s51, s51, 7
    s_lshl_b32 s54, s32, 11
    s_add_u32 m0, s54, 32768
    s_nop 0
    buffer_load_dwordx4 v24, s[12:15], s51 offen lds
    s_add_u32 m0, s54, 33792
    s_nop 0
    buffer_load_dwordx4 v25, s[12:15], s51 offen lds
    s_add_u32 s51, s3, 3
    s_and_b32 s51, s51, 7
    s_lshl_b32 s51, s51, 7
    s_lshl_b32 s54, s32, 11
    s_add_u32 m0, s54, 49152
    s_nop 0
    buffer_load_dwordx4 v24, s[12:15], s51 offen lds
    s_add_u32 m0, s54, 50176
    s_nop 0
    buffer_load_dwordx4 v25, s[12:15], s51 offen lds
    s_and_b32 s43, s32, 1
    s_bfe_u32 s44, s32, 0x10001
    s_lshr_b32 s45, s32, 2
    v_lshlrev_b32 v4, 4, v1
    s_and_b32 s46, s32, 3
    s_lshl_b32 s47, s46, 16
    s_lshl_b32 s48, s45, 21
    s_add_u32 s47, s47, s48
    v_add_u32 v4, s47, v4
    s_lshl_b32 s50, s32, 11
    s_lshl_b32 s48, s4, 1
    s_lshl_b32 s49, s4, 4
    s_lshr_b32 s54, s6, 1
    s_lshl_b32 s54, s54, 6
    s_add_u32 s54, s54, 0x622000
    s_lshl_b32 s55, s7, 6
    s_add_u32 s55, s55, 0x622400
    v_and_b32 v29, 7, v1
    v_lshlrev_b32 v29, 2, v29
    v_add_u32 v30, s54, v29
    v_and_b32 v29, 15, v1
    v_lshlrev_b32 v29, 2, v29
    v_add_u32 v31, s55, v29
    s_mov_b32 s10, 0x200000
    s_mov_b32 s11, 0x20000
    s_mov_b32 s22, 0x400000
    s_mov_b32 s23, 0x20000
    v_and_b32 v26, 15, v1
    v_lshrrev_b32 v27, 2, v26
    v_and_b32 v26, 3, v1
    v_lshrrev_b32 v28, 4, v1
    v_and_b32 v29, 1, v28
    v_lshl_add_u32 v26, v29, 2, v26
    v_and_b32 v29, 1, v26
    v_lshlrev_b32 v29, 2, v29
    v_lshrrev_b32 v26, 1, v26
    v_add_u32 v26, v26, v29
    v_lshrrev_b32 v28, 1, v28
    v_lshlrev_b32 v28, 10, v28
    v_and_b32 v29, 1, v26
    v_lshl_add_u32 v28, v29, 3, v28
    v_lshrrev_b32 v29, 1, v26
    v_lshl_add_u32 v28, v29, 7, v28
    v_lshrrev_b32 v29, 2, v26
    v_lshl_add_u32 v27, v29, 2, v27
    v_lshl_add_u32 v28, v27, 4, v28
    s_lshl_b32 s54, s45, 13
    s_lshl_b32 s55, s43, 9
    s_add_u32 s54, s54, s55
    v_add_u32 v8, s54, v28
    v_xor_b32 v7, 64, v8
    v_and_b32 v26, 31, v1
    v_lshrrev_b32 v27, 5, v1
    v_bfe_u32 v28, v26, 1, 3
    v_xor_b32 v28, v28, v27
    v_lshlrev_b32 v28, 4, v28
    v_lshl_add_u32 v28, v26, 7, v28
    s_lshl_b32 s54, s45, 13
    s_lshl_b32 s55, s44, 12
    s_add_u32 s54, s54, s55
    v_add_u32 v9, s54, v28
    v_xor_b32 v10, 32, v9
    v_xor_b32 v11, 64, v9
    v_xor_b32 v12, 96, v9
    v_lshrrev_b32 v26, 5, v1
    v_and_b32 v27, 31, v1
    s_lshl_b32 s54, s43, 5
    s_lshl_b32 s55, s45, 3
    s_add_u32 s54, s54, s55
    v_lshl_add_u32 v26, v26, 4, s54
    s_lshl_b32 s55, s44, 5
    v_add_u32 v27, s55, v27
    v_lshlrev_b32 v47, 2, v26
    v_lshlrev_b32 v28, 2, v27
    v_lshl_add_u32 v15, v26, 11, v28
    v_add_u32 v16, s5, v27
    v_lshlrev_b32 v16, 1, v16
    v_lshlrev_b32 v28, 1, v26
    v_lshl_add_u32 v46, v27, 7, v28
    v_add_u32 v46, 139264, v46
    v_and_b32 v28, 15, v1
    v_lshrrev_b32 v28, 2, v28
    v_add_u32 v28, v28, v26
    v_lshlrev_b32 v28, 7, v28
    v_bfe_u32 v29, v1, 4, 1
    v_lshl_add_u32 v28, v29, 5, v28
    v_and_b32 v29, 3, v1
    v_lshl_add_u32 v28, v29, 3, v28
    s_lshl_b32 s55, s44, 6
    s_add_u32 s55, s55, 131072
    v_add_u32 v45, s55, v28
    v_lshrrev_b32 v28, 3, v1
    s_lshl_b32 s54, s32, 3
    v_add_u32 v28, s54, v28
    v_and_b32 v29, 7, v1
    v_lshlrev_b32 v29, 4, v29
    v_lshl_add_u32 v13, v28, 10, v29
    v_lshl_add_u32 v14, v28, 12, v29
    s_branch L_TAIL
L_F_last:
    s_endpgm
.section .rodata,"a"
.p2align 6
.amdhsa_kernel gated_mix__ssm_conv_s5__ssm_conv_s4d__prompt_kernel
  .amdhsa_next_free_vgpr 256
  .amdhsa_next_free_sgpr 102
  .amdhsa_accum_offset 256
  .amdhsa_group_segment_fixed_size 0
  .amdhsa_kernarg_size 160
  .amdhsa_user_sgpr_count 2
  .amdhsa_user_sgpr_kernarg_segment_ptr 1
  .amdhsa_system_sgpr_workgroup_id_x 1
  .amdhsa_float_denorm_mode_32 3
.end_amdhsa_kernel
```
